```python
import torch

def _softmax(x, axis=-1):
    return torch.softmax(x, dim=axis)
def _gelu(x):
    return torch.nn.functional.gelu(x, approximate="tanh")
def _silu(x):
    return torch.nn.functional.silu(x)
def _sigmoid(x):
    return torch.sigmoid(x)
def _layernorm(x, axis=-1, eps=1e-5):
    m = x.mean(dim=axis, keepdim=True)
    v = x.var(dim=axis, keepdim=True, unbiased=False)
    return (x - m) / torch.sqrt(v + eps)
def _scatter_add(tgt, idx, src, axis=0):
    return tgt.clone().index_add_(axis, idx, src)
def _segment_sum(src, seg, n):
    out = torch.zeros((n,) + src.shape[1:], dtype=src.dtype)
    return out.index_add_(0, seg, src)
def _pad(x, pw):
    flat = tuple(v for pair in reversed(pw) for v in pair)
    return torch.nn.functional.pad(x, flat)

kernel_name = 'gated_mix__mha_block__ssm_conv_s4__prompt'

def setup_inputs():

    _w = (lambda a: (lambda t: t.to(torch.bfloat16) if t.is_floating_point() else t)(torch.as_tensor(a)))
    def _A_setup():
        B, S, D, H = 1, 2048, 448, 16
        return {
            "x": _w((lambda *s: torch.randn(*s, dtype=torch.bfloat16) * 0.05)(B, S, D)),
            "wqkv": _w((lambda *s: torch.randn(*s, dtype=torch.bfloat16) * 0.8)(D, 3 * D)),
            "wo": _w((lambda *s: torch.randn(*s, dtype=torch.bfloat16) * 0.05)(D, D)),
        }
    _A_in = _A_setup()

    def _B_setup():
        B, L, D, N = 1, 2048, 448, 256
        A_re = -(lambda _x: torch.exp(torch.as_tensor(_x)))((lambda *s: torch.randn(*s, dtype=torch.bfloat16) * 6.4)(D, N))
        A_im = torch.pi * (lambda *s: torch.randn(*s, dtype=torch.bfloat16) * 0.1)(D, N)
        B_re = (lambda *s: torch.randn(*s, dtype=torch.bfloat16) * 0.2)(D, N)
        B_im = (lambda *s: torch.randn(*s, dtype=torch.bfloat16) * 0.2)(D, N)
        C_re = (lambda *s: torch.randn(*s, dtype=torch.bfloat16) * 0.2)(D, N)
        C_im = (lambda *s: torch.randn(*s, dtype=torch.bfloat16) * 0.2)(D, N)
        log_dt = (lambda *s: torch.randn(*s, dtype=torch.bfloat16) * 0.1)(D) * 0.5 - 4.0
        Dskip = (lambda *s: torch.randn(*s, dtype=torch.bfloat16) * 0.1)(D)
        return {
            "u": _w((lambda *s: torch.randn(*s, dtype=torch.bfloat16) * 0.05)(B, L, D)),
            "A_re": _w(A_re),
            "A_im": _w(A_im),
            "B_re": _w(B_re),
            "B_im": _w(B_im),
            "C_re": _w(C_re),
            "C_im": _w(C_im),
            "log_dt": _w(log_dt),
            "Dskip": _w(Dskip),
        }
    _B_in = _B_setup()

    return {
        "A_x": _A_in["x"],
        "A_wqkv": _A_in["wqkv"],
        "A_wo": _A_in["wo"],
        "B_u": _B_in["u"],
        "B_A_re": _B_in["A_re"],
        "B_A_im": _B_in["A_im"],
        "B_B_re": _B_in["B_re"],
        "B_B_im": _B_in["B_im"],
        "B_C_re": _B_in["C_re"],
        "B_C_im": _B_in["C_im"],
        "B_log_dt": _B_in["log_dt"],
        "B_Dskip": _B_in["Dskip"],
        "gate_w": _w((lambda *s: torch.randn(*s, dtype=torch.bfloat16) * 0.05)(448) * 16.0),
    }

def reference(A_x, A_wqkv, A_wo, B_u, B_A_re, B_A_im, B_B_re, B_B_im, B_C_re, B_C_im, B_log_dt, B_Dskip, gate_w):
    def _A_ref(x, wqkv, wo):
        B, S, D = x.shape
        H = 16
        Dh = D // H
        qkv = (lambda x, *d: x.permute(*d))((x @ wqkv).reshape(B, S, 3, H, Dh), 2, 0, 3, 1, 4)
        q, k, v = qkv[0], qkv[1], qkv[2]
        scores = torch.einsum("bhqd,bhkd->bhqk", q, k) * (Dh ** -0.5)
        p = _softmax(scores, axis=-1)
        o = torch.einsum("bhqk,bhkd->bhqd", p, v)
        return (lambda x, *d: x.permute(*d))(o, 0, 2, 1, 3).reshape(B, S, D) @ wo

    def _B_ref(u, A_re, A_im, B_re, B_im, C_re, C_im, log_dt, Dskip):
        Bsz, L, D = u.shape
        dt = torch.exp(log_dt)[:, None]
        A = A_re + 1j * A_im
        Bc = B_re + 1j * B_im
        Cc = C_re + 1j * C_im
        logdA = dt * A
        dB = dt * Bc
        l = (lambda x, dt: x.to(dt))(torch.arange(L), A_re.dtype)
        P = torch.exp(logdA[:, :, None] * l[None, None, :])
        K = torch.einsum("dn,dnl,dn->dl", Cc, P, dB).real
        L2 = 2 * L
        Kp = _pad(K, ((0, 0), (0, L)))
        up = (lambda x, *d: x.permute(*d))(u, 0, 2, 1)
        up = _pad(up, ((0, 0), (0, 0), (0, L)))
        Kf = (lambda x, axes=(-2,-1): torch.fft.rfft2(x.float(), dim=axes))(Kp[:, None, :], axes=(-2, -1))
        Uf = (lambda x, axes=(-2,-1): torch.fft.rfft2(x.float(), dim=axes))(up[:, :, None, :], axes=(-2, -1))
        Yf = Uf * Kf[None, :, :, :]
        y = (lambda x, s, axes=(-2,-1): torch.fft.irfft2(x, s=s, dim=axes).to(torch.bfloat16))(Yf, (1, L2), axes=(-2, -1))[:, :, 0, :L]
        y = (lambda x, *d: x.permute(*d))(y, 0, 2, 1) + u * Dskip[None, None, :]
        return y

    x = A_x
    g = _sigmoid((x * gate_w).sum(-1, keepdims=True))
    a = _A_ref(x, A_wqkv, A_wo)
    b = _B_ref(x, B_A_re, B_A_im, B_B_re, B_B_im, B_C_re, B_C_im, B_log_dt, B_Dskip)
    return g * a + (1 - g) * b
```

```asm
; @launch grid=(512,1,1) block=(256,1,1) lds=81920
.amdgcn_target "amdgcn-amd-amdhsa--gfx950"
.text
.globl gated_mix__mha_block__ssm_conv_s4__prompt_kernel
.p2align 8
.type gated_mix__mha_block__ssm_conv_s4__prompt_kernel,@function
gated_mix__mha_block__ssm_conv_s4__prompt_kernel:
    s_cmp_ge_u32 s2, 512
    s_cbranch_scc1 L_END
    s_load_dwordx16 s[64:79], s[0:1], 0
    s_load_dwordx16 s[80:95], s[0:1], 64
    s_cmp_lt_u32 s2, 504
    s_cbranch_scc1 E_NOPF
    s_getpc_b64 s[4:5]
E_PC:
    v_lshlrev_b32 v4, 7, v0
    v_min_u32 v4, L_END-E_PC, v4
    v_mov_b32 v5, s5
    v_add_co_u32 v4, vcc, s4, v4
    s_nop 1
    v_addc_co_u32 v5, vcc, 0, v5, vcc
    global_load_dword v6, v[4:5], off
E_NOPF:
    v_lshrrev_b32 v13, 6, v0
    v_and_b32 v1, 63, v0
    v_lshlrev_b32 v2, 4, v1
    v_mov_b32 v255, 0
    v_readfirstlane_b32 s24, v13
    s_and_b32 s31, s2, 7
    s_bfe_u32 s32, s2, 0x50003
    s_cmp_ge_u32 s2, 256
    s_cbranch_scc1 L_A
    s_and_b32 s27, s24, 1
    s_cmp_ge_u32 s32, 28
    s_cbranch_scc1 L_C
    s_setprio 3
    s_lshl_b32 s39, s32, 1
    s_and_b32 s34, s31, 3
    s_mul_i32 s34, s34, 56
    s_add_u32 s26, s39, s34
    s_lshr_b32 s34, s24, 1
    s_add_u32 s26, s26, s34
    s_lshl_b32 s26, s26, 1
    s_lshr_b32 s34, s31, 2
    s_add_u32 s26, s26, s34
    s_lshl_b32 s33, s26, 9
    s_lshl_b32 s34, s27, 8
    s_add_u32 s33, s33, s34
    v_lshlrev_b32 v3, 2, v1
    v_add_u32 v13, s33, v3
    s_lshl_b32 s34, s26, 1
    s_and_b32 s34, s34, -4
    v_lshlrev_b32 v4, 7, v0
    s_lshl_b32 s33, s2, 15
    s_add_u32 s33, s33, 6750208
    s_waitcnt lgkmcnt(0)
    s_mov_b32 s20, s94
    s_mov_b32 s21, s95
    s_mov_b32 s22, 11075584
    s_mov_b32 s23, 0x00020000
    s_cmp_ge_u32 s2, 2
    s_cbranch_scc1 E_NOINIT
    buffer_store_dword v255, v4, s[20:23], s33 offen sc1
E_NOINIT:
    global_load_dword v244, v13, s[72:73]
    global_load_dword v245, v13, s[74:75]
    global_load_dword v246, v13, s[76:77]
    global_load_dword v247, v13, s[78:79]
    global_load_dword v248, v13, s[80:81]
    global_load_dword v249, v13, s[82:83]
    s_load_dword s28, s[84:85], s34
    s_load_dword s38, s[86:87], s34
    s_branch L_B
L_A:
    s_setprio 2
    s_lshr_b32 s33, s31, 1
    s_lshl_b32 s33, s33, 2
    s_and_b32 s34, s32, 3
    s_add_u32 s25, s33, s34
    s_and_b32 s27, s31, 1
    s_lshr_b32 s54, s32, 2
    s_lshl_b32 s33, s27, 3
    s_add_u32 s26, s33, s54
    s_lshl_b32 s33, s25, 2
    s_add_u32 s35, s33, s24
    s_mul_i32 s33, s35, 28672
    v_lshrrev_b32 v13, 3, v1
    v_mul_u32_u24 v12, 896, v13
    v_and_b32 v14, 7, v1
    v_lshrrev_b32 v15, 4, v1
    v_xor_b32 v15, v15, v14
    v_lshl_add_u32 v3, v15, 4, v12
    v_add_u32 v3, s33, v3
    v_xor_b32 v246, 64, v3
    v_add_u32 v244, 6144, v246
    v_add_u32 v245, 12288, v3
    v_add_u32 v246, 18432, v246
    s_mul_i32 s40, s24, 12288
    s_add_u32 s40, s40, 32768
    s_lshl_b32 s33, s34, 1
    s_add_u32 s28, s33, s54
    s_sub_u32 s33, s28, 7
    s_cmp_ge_u32 s28, 7
    s_cselect_b32 s28, s33, s28
    s_lshl_b32 s29, s28, 7
    s_mul_i32 s37, s28, 172032
    s_mov_b32 s39, s37
    v_bfe_u32 v15, v1, 4, 1
    v_lshlrev_b32 v15, 2, v15
    v_xor_b32 v15, v15, v14
    v_mul_u32_u24 v4, 2688, v13
    v_lshl_add_u32 v4, v15, 4, v4
    s_min_u32 s55, s54, 6
    s_mul_i32 s33, s24, 43008
    s_mul_i32 s34, s27, 896
    s_add_u32 s33, s33, s34
    s_lshl_b32 s34, s55, 7
    s_add_u32 s33, s33, s34
    s_add_u32 s33, s33, 896
    v_add_u32 v4, s33, v4
    v_add_u32 v5, 20480, v4
    s_lshl_b32 s36, s24, 11
    s_lshl_b32 s47, s25, 4
    s_add_u32 s47, s47, s26
    s_mul_i32 s48, s47, 7168
    s_mul_i32 s33, s24, 224
    s_add_u32 s48, s48, s33
    s_add_u32 s49, s48, 3584
    v_lshlrev_b32 v7, 2, v1
    s_waitcnt lgkmcnt(0)
    s_mov_b32 s12, s64
    s_mov_b32 s13, s65
    s_mov_b32 s14, 1835008
    s_mov_b32 s15, 0x00020000
    s_mov_b32 s16, s66
    s_mov_b32 s17, s67
    s_mov_b32 s18, 1204224
    s_mov_b32 s19, 0x00020000
    s_mov_b32 s20, s94
    s_mov_b32 s21, s95
    s_mov_b32 s22, 11075584
    s_mov_b32 s23, 0x00020000
    s_cmp_eq_u32 s54, 7
    s_cbranch_scc1 A_GOL
    s_add_u32 m0, s40, 0
    s_nop 0
    buffer_load_dwordx4 v3, s[12:15], s29 offen offset:0 lds
    buffer_load_dwordx4 v244, s[12:15], s29 offen offset:1024 lds
    buffer_load_dwordx4 v245, s[12:15], s29 offen offset:2048 lds
    buffer_load_dwordx4 v246, s[12:15], s29 offen offset:3072 lds
    s_add_u32 m0, s36, 0
    s_nop 0
    buffer_load_dwordx4 v4, s[16:19], s37 offen offset:0 lds
    buffer_load_dwordx4 v5, s[16:19], s37 offen offset:1024 lds
    s_add_u32 m0, s40, 4096
    s_add_u32 s29, s29, 128
    s_cmp_eq_u32 s29, 896
    s_cselect_b32 s29, 0, s29
    buffer_load_dwordx4 v3, s[12:15], s29 offen offset:0 lds
    buffer_load_dwordx4 v244, s[12:15], s29 offen offset:1024 lds
A_GO:
    buffer_load_dword v128, v7, s[12:15], s48 offen offset:0
    buffer_load_dword v129, v7, s[12:15], s48 offen offset:896
    buffer_load_dword v130, v7, s[12:15], s48 offen offset:1792
    buffer_load_dword v131, v7, s[12:15], s48 offen offset:2688
    buffer_load_dword v132, v7, s[12:15], s49 offen offset:0
    buffer_load_dword v133, v7, s[12:15], s49 offen offset:896
    buffer_load_dword v134, v7, s[12:15], s49 offen offset:1792
    buffer_load_dword v135, v7, s[12:15], s49 offen offset:2688
    v_and_b32 v13, 31, v1
    v_bfe_u32 v14, v1, 1, 3
    v_lshrrev_b32 v15, 5, v1
    v_xor_b32 v14, v14, v15
    v_lshlrev_b32 v13, 7, v13
    v_lshl_add_u32 v8, v14, 4, v13
    v_add_u32 v8, s40, v8
    v_xor_b32 v9, 32, v8
    v_xor_b32 v10, 64, v8
    v_xor_b32 v11, 96, v8
    v_bfe_u32 v240, v1, 2, 2
    v_lshl_add_u32 v241, v15, 3, v240
    v_bfe_u32 v242, v1, 4, 1
    v_and_b32 v243, 3, v1
    v_lshl_add_u32 v224, v242, 2, v243
    v_and_b32 v225, 1, v1
    v_bfe_u32 v226, v1, 1, 1
    v_lshl_add_u32 v225, v225, 1, v226
    v_lshl_add_u32 v225, v242, 2, v225
    v_bfe_u32 v243, v1, 3, 1
    v_lshlrev_b32 v243, 6, v243
    v_lshl_add_u32 v243, v241, 7, v243
    s_cmp_eq_u32 s27, 1
    s_cselect_b64 vcc, -1, 0
    v_cndmask_b32 v12, v225, v224, vcc
    v_lshl_add_u32 v12, v12, 3, v243
    v_xor_b32 v13, 64, v12
    v_add_u32 v226, 2, v225
    v_sub_u32 v227, 7, v225
    v_cmp_gt_u32 vcc, 6, v225
    s_bitcmp1_b32 s26, 0
    s_cselect_b64 s[4:5], -1, 0
    v_cndmask_b32 v226, v227, v226, vcc
    v_cndmask_b32 v226, v225, v226, s[4:5]
    v_lshlrev_b32 v15, 6, v241
    v_lshl_add_u32 v15, v226, 3, v15
    v_add_u32 v15, 36864, v15
    v_lshrrev_b32 v14, 2, v1
    v_mul_u32_u24 v14, 2688, v14
    v_and_b32 v240, 3, v1
    v_lshl_add_u32 v14, v240, 4, v14
    s_mul_i32 s33, s26, 56
    s_and_b32 s33, s33, -16
    s_mul_i32 s34, s24, 43008
    s_add_u32 s33, s33, s34
    v_add_u32 v14, s33, v14
    s_mul_i32 s33, s54, 2341
    s_lshr_b32 s33, s33, 10
    v_add_u32 v224, s33, v1
    v_mul_u32_u24 v225, 28, v224
    v_lshrrev_b32 v225, 6, v225
    v_cmp_ge_u32 s[56:57], s54, v225
    v_lshlrev_b32 v243, 11, v224
    s_lshl_b32 s42, s25, 7
    s_add_u32 s42, s42, 6750208
    s_and_b64 s[56:57], s[56:57], 15
    s_mul_i32 s48, s47, 7296
    s_mul_i32 s33, s24, 896
    s_add_u32 s48, s48, s33
    s_add_u32 s48, s48, 4194304
    s_lshr_b32 s49, s25, 2
    s_lshl_b32 s49, s49, 10
    s_add_u32 s49, s49, 6799360
    v_lshlrev_b32 v7, 7, v1
    s_mov_b32 s50, 0x05040100
    s_mov_b32 s51, 0x07060302
    s_cmp_eq_u32 s54, 7
    s_cbranch_scc1 A_LIGHT
    s_cmp_eq_u32 s27, 1
    s_cbranch_scc1 A_V
    v_mov_b32 v247, v2
    s_mul_i32 s38, s35, 28672
    s_lshl_b32 s33, s55, 12
    s_add_u32 s38, s38, s33
    s_add_u32 s41, s38, 1024
    s_add_u32 s43, s38, 2048
    s_add_u32 s44, s38, 3072
    buffer_load_dwordx4 v245, s[12:15], s29 offen offset:2048 lds
    buffer_load_dwordx4 v246, s[12:15], s29 offen offset:3072 lds
    s_add_u32 m0, s36, 8192
    s_add_u32 s37, s37, 172032
    s_cmp_eq_u32 s37, 1204224
    s_cselect_b32 s37, 0, s37
    buffer_load_dwordx4 v4, s[16:19], s37 offen offset:0 lds
    buffer_load_dwordx4 v5, s[16:19], s37 offen offset:1024 lds
    s_add_u32 m0, s40, 8192
    s_add_u32 s29, s29, 128
    s_cmp_eq_u32 s29, 896
    s_cselect_b32 s29, 0, s29
    buffer_load_dwordx4 v3, s[12:15], s29 offen offset:0 lds
    buffer_load_dwordx4 v244, s[12:15], s29 offen offset:1024 lds
    buffer_load_dwordx4 v245, s[12:15], s29 offen offset:2048 lds
    buffer_load_dwordx4 v246, s[12:15], s29 offen offset:3072 lds
    s_waitcnt vmcnt(20)
    ds_read_b128 v[16:19], v8 offset:0
    ds_read_b128 v[20:23], v9 offset:0
    ds_read_b128 v[24:27], v10 offset:0
    ds_read_b128 v[28:31], v11 offset:0
    s_add_u32 m0, s36, 16384
    s_add_u32 s37, s37, 172032
    s_cmp_eq_u32 s37, 1204224
    s_cselect_b32 s37, 0, s37
    buffer_load_dwordx4 v4, s[16:19], s37 offen offset:0 lds
    s_waitcnt vmcnt(19)
    s_barrier
    s_cmp_lg_u32 s24, 0
    s_cbranch_scc1 NI1
    global_load_dword v248, v255, s[92:93] sc1
NI1:
    ds_read_b64_tr_b16 v[176:177], v12 offset:0
    ds_read_b64_tr_b16 v[178:179], v12 offset:512
    s_waitcnt lgkmcnt(2)
    buffer_load_dwordx4 v5, s[16:19], s37 offen offset:1024 lds
    ds_read_b64_tr_b16 v[180:181], v13 offset:0
    ds_read_b64_tr_b16 v[182:183], v13 offset:512
    s_add_u32 m0, s40, 0
    s_add_u32 s29, s29, 128
    s_cmp_eq_u32 s29, 896
    s_cselect_b32 s29, 0, s29
    buffer_load_dwordx4 v3, s[12:15], s29 offen offset:0 lds
    ds_read_b64_tr_b16 v[184:185], v12 offset:2048
    ds_read_b64_tr_b16 v[186:187], v12 offset:2560
    buffer_load_dwordx4 v244, s[12:15], s29 offen offset:1024 lds
    ds_read_b64_tr_b16 v[188:189], v13 offset:2048
    ds_read_b64_tr_b16 v[190:191], v13 offset:2560
    s_waitcnt vmcnt(12)
    s_mov_b32 exec_hi, 0xffffff
    v_perm_b32 v136, v129, v128, s50
    v_perm_b32 v137, v131, v130, s50
    v_perm_b32 v138, v133, v132, s50
    v_perm_b32 v139, v135, v134, s50
    buffer_store_dwordx4 v[136:139], v2, s[20:23], s48 offen offset:0 sc1
    v_perm_b32 v140, v129, v128, s51
    v_perm_b32 v141, v131, v130, s51
    v_perm_b32 v142, v133, v132, s51
    v_perm_b32 v143, v135, v134, s51
    buffer_store_dwordx4 v[140:143], v2, s[20:23], s48 offen offset:3584 sc1
    s_mov_b64 exec, -1
    buffer_load_dwordx4 v245, s[12:15], s29 offen offset:2048 lds
    ds_read_b64_tr_b16 v[192:193], v12 offset:4096
    ds_read_b64_tr_b16 v[194:195], v12 offset:4608
    buffer_load_dwordx4 v246, s[12:15], s29 offen offset:3072 lds
    ds_read_b64_tr_b16 v[196:197], v13 offset:4096
    ds_read_b64_tr_b16 v[198:199], v13 offset:4608
    s_waitcnt lgkmcnt(8)
    v_mfma_f32_32x32x16_bf16 v[128:143], v[176:179], v[16:19], 0
    s_add_u32 m0, s36, 24576
    s_add_u32 s37, s37, 172032
    s_cmp_eq_u32 s37, 1204224
    s_cselect_b32 s37, 0, s37
    buffer_load_dwordx4 v4, s[16:19], s37 offen offset:0 lds
    ds_read_b64_tr_b16 v[200:201], v12 offset:6144
    ds_read_b64_tr_b16 v[202:203], v12 offset:6656
    v_mfma_f32_32x32x16_bf16 v[144:159], v[180:183], v[16:19], 0
    buffer_load_dwordx4 v5, s[16:19], s37 offen offset:1024 lds
    ds_read_b64_tr_b16 v[204:205], v13 offset:6144
    ds_read_b64_tr_b16 v[206:207], v13 offset:6656
    s_waitcnt vmcnt(16)
    ds_read_b128 v[32:35], v8 offset:4096
    ds_read_b128 v[36:39], v9 offset:4096
    ds_read_b128 v[40:43], v10 offset:4096
    ds_read_b128 v[44:47], v11 offset:4096
    s_waitcnt lgkmcnt(12)
    v_mfma_f32_32x32x16_bf16 v[128:143], v[184:187], v[20:23], v[128:143]
    s_waitcnt vmcnt(14)
    s_barrier
    ds_read_b64_tr_b16 v[208:209], v12 offset:8192
    ds_read_b64_tr_b16 v[210:211], v12 offset:8704
    v_mfma_f32_32x32x16_bf16 v[144:159], v[188:191], v[20:23], v[144:159]
    s_waitcnt lgkmcnt(2)
    s_add_u32 m0, s40, 4096
    s_add_u32 s29, s29, 128
    s_cmp_eq_u32 s29, 896
    s_cselect_b32 s29, 0, s29
    buffer_load_dwordx4 v3, s[12:15], s29 offen offset:0 lds
    ds_read_b64_tr_b16 v[212:213], v13 offset:8192
    ds_read_b64_tr_b16 v[214:215], v13 offset:8704
    s_waitcnt lgkmcnt(12)
    v_mfma_f32_32x32x16_bf16 v[128:143], v[192:195], v[24:27], v[128:143]
    buffer_load_dwordx4 v244, s[12:15], s29 offen offset:1024 lds
    ds_read_b64_tr_b16 v[216:217], v12 offset:10240
    ds_read_b64_tr_b16 v[218:219], v12 offset:10752
    v_mfma_f32_32x32x16_bf16 v[144:159], v[196:199], v[24:27], v[144:159]
    buffer_load_dwordx4 v245, s[12:15], s29 offen offset:2048 lds
    ds_read_b64_tr_b16 v[220:221], v13 offset:10240
    ds_read_b64_tr_b16 v[222:223], v13 offset:10752
    s_waitcnt lgkmcnt(12)
    v_mfma_f32_32x32x16_bf16 v[128:143], v[200:203], v[28:31], v[128:143]
    buffer_load_dwordx4 v246, s[12:15], s29 offen offset:3072 lds
    ds_read_b64_tr_b16 v[176:177], v12 offset:12288
    ds_read_b64_tr_b16 v[178:179], v12 offset:12800
    v_mfma_f32_32x32x16_bf16 v[144:159], v[204:207], v[28:31], v[144:159]
    ds_read_b64_tr_b16 v[180:181], v13 offset:12288
    ds_read_b64_tr_b16 v[182:183], v13 offset:12800
    s_waitcnt lgkmcnt(8)
    v_mfma_f32_32x32x16_bf16 v[128:143], v[208:211], v[32:35], v[128:143]
    ds_read_b64_tr_b16 v[184:185], v12 offset:14336
    ds_read_b64_tr_b16 v[186:187], v12 offset:14848
    v_mfma_f32_32x32x16_bf16 v[144:159], v[212:215], v[32:35], v[144:159]
    ds_read_b64_tr_b16 v[188:189], v13 offset:14336
    ds_read_b64_tr_b16 v[190:191], v13 offset:14848
    s_waitcnt vmcnt(14)
    ds_read_b128 v[48:51], v8 offset:8192
    ds_read_b128 v[52:55], v9 offset:8192
    ds_read_b128 v[56:59], v10 offset:8192
    ds_read_b128 v[60:63], v11 offset:8192
    s_waitcnt lgkmcnt(12)
    v_mfma_f32_32x32x16_bf16 v[128:143], v[216:219], v[36:39], v[128:143]
    s_waitcnt vmcnt(12)
    s_barrier
    ds_read_b64_tr_b16 v[192:193], v12 offset:16384
    ds_read_b64_tr_b16 v[194:195], v12 offset:16896
    v_mfma_f32_32x32x16_bf16 v[144:159], v[220:223], v[36:39], v[144:159]
    s_waitcnt lgkmcnt(2)
    s_add_u32 m0, s36, 0
    s_add_u32 s37, s37, 172032
    s_cmp_eq_u32 s37, 1204224
    s_cselect_b32 s37, 0, s37
    buffer_load_dwordx4 v4, s[16:19], s37 offen offset:0 lds
    ds_read_b64_tr_b16 v[196:197], v13 offset:16384
    ds_read_b64_tr_b16 v[198:199], v13 offset:16896
    s_waitcnt lgkmcnt(12)
    v_mfma_f32_32x32x16_bf16 v[128:143], v[176:179], v[40:43], v[128:143]
    buffer_load_dwordx4 v5, s[16:19], s37 offen offset:1024 lds
    ds_read_b64_tr_b16 v[200:201], v12 offset:18432
    ds_read_b64_tr_b16 v[202:203], v12 offset:18944
    v_mfma_f32_32x32x16_bf16 v[144:159], v[180:183], v[40:43], v[144:159]
    s_add_u32 m0, s40, 8192
    s_add_u32 s29, s29, 128
    s_cmp_eq_u32 s29, 896
    s_cselect_b32 s29, 0, s29
    buffer_load_dwordx4 v3, s[12:15], s29 offen offset:0 lds
    ds_read_b64_tr_b16 v[204:205], v13 offset:18432
    ds_read_b64_tr_b16 v[206:207], v13 offset:18944
    s_waitcnt lgkmcnt(12)
    v_mfma_f32_32x32x16_bf16 v[128:143], v[184:187], v[44:47], v[128:143]
    buffer_load_dwordx4 v244, s[12:15], s29 offen offset:1024 lds
    ds_read_b64_tr_b16 v[208:209], v12 offset:20480
    ds_read_b64_tr_b16 v[210:211], v12 offset:20992
    v_mfma_f32_32x32x16_bf16 v[144:159], v[188:191], v[44:47], v[144:159]
    buffer_load_dwordx4 v245, s[12:15], s29 offen offset:2048 lds
    ds_read_b64_tr_b16 v[212:213], v13 offset:20480
    ds_read_b64_tr_b16 v[214:215], v13 offset:20992
    s_waitcnt lgkmcnt(8)
    v_mfma_f32_32x32x16_bf16 v[128:143], v[192:195], v[48:51], v[128:143]
    buffer_load_dwordx4 v246, s[12:15], s29 offen offset:3072 lds
    ds_read_b64_tr_b16 v[216:217], v12 offset:22528
    ds_read_b64_tr_b16 v[218:219], v12 offset:23040
    v_mfma_f32_32x32x16_bf16 v[144:159], v[196:199], v[48:51], v[144:159]
    ds_read_b64_tr_b16 v[220:221], v13 offset:22528
    ds_read_b64_tr_b16 v[222:223], v13 offset:23040
    s_waitcnt vmcnt(12)
    ds_read_b128 v[64:67], v8 offset:0
    ds_read_b128 v[68:71], v9 offset:0
    ds_read_b128 v[72:75], v10 offset:0
    ds_read_b128 v[76:79], v11 offset:0
    s_waitcnt lgkmcnt(12)
    v_mfma_f32_32x32x16_bf16 v[128:143], v[200:203], v[52:55], v[128:143]
    s_waitcnt vmcnt(10)
    s_barrier
    s_cmp_lg_u32 s24, 0
    s_cbranch_scc1 ND2
    s_mov_b32 s62, 40000
NT2:
    v_readfirstlane_b32 s60, v248
    s_nop 1
    s_cmp_ge_u32 s60, 8
    s_cbranch_scc1 ND2
    s_sub_u32 s62, s62, 1
    s_cbranch_scc1 ND2
    s_sleep 8
    global_load_dword v248, v255, s[92:93] sc1
    s_waitcnt vmcnt(0)
    s_branch NT2
ND2:
    s_cmp_lg_u32 s24, 0
    s_cbranch_scc1 XPK
    v_mov_b32 v249, 1
    s_mov_b64 exec, 0xff
    buffer_atomic_add v249, v7, s[20:23], s49 offen sc1
    s_mov_b64 exec, -1
XPK:
    ds_read_b64_tr_b16 v[176:177], v12 offset:24576
    ds_read_b64_tr_b16 v[178:179], v12 offset:25088
    v_mfma_f32_32x32x16_bf16 v[144:159], v[204:207], v[52:55], v[144:159]
    s_waitcnt lgkmcnt(2)
    s_add_u32 m0, s36, 8192
    s_add_u32 s37, s37, 172032
    s_cmp_eq_u32 s37, 1204224
    s_cselect_b32 s37, 0, s37
    buffer_load_dwordx4 v4, s[16:19], s37 offen offset:0 lds
    ds_read_b64_tr_b16 v[180:181], v13 offset:24576
    ds_read_b64_tr_b16 v[182:183], v13 offset:25088
    s_waitcnt lgkmcnt(12)
    v_mfma_f32_32x32x16_bf16 v[128:143], v[208:211], v[56:59], v[128:143]
    buffer_load_dwordx4 v5, s[16:19], s37 offen offset:1024 lds
    ds_read_b64_tr_b16 v[184:185], v12 offset:26624
    ds_read_b64_tr_b16 v[186:187], v12 offset:27136
    v_mfma_f32_32x32x16_bf16 v[144:159], v[212:215], v[56:59], v[144:159]
    s_add_u32 m0, s40, 0
    s_add_u32 s29, s29, 128
    s_cmp_eq_u32 s29, 896
    s_cselect_b32 s29, 0, s29
    buffer_load_dwordx4 v3, s[12:15], s29 offen offset:0 lds
    ds_read_b64_tr_b16 v[188:189], v13 offset:26624
    ds_read_b64_tr_b16 v[190:191], v13 offset:27136
    s_waitcnt lgkmcnt(12)
    v_mfma_f32_32x32x16_bf16 v[128:143], v[216:219], v[60:63], v[128:143]
    buffer_load_dwordx4 v244, s[12:15], s29 offen offset:1024 lds
    ds_read_b64_tr_b16 v[192:193], v12 offset:28672
    ds_read_b64_tr_b16 v[194:195], v12 offset:29184
    v_mfma_f32_32x32x16_bf16 v[144:159], v[220:223], v[60:63], v[144:159]
    buffer_load_dwordx4 v245, s[12:15], s29 offen offset:2048 lds
    ds_read_b64_tr_b16 v[196:197], v13 offset:28672
    ds_read_b64_tr_b16 v[198:199], v13 offset:29184
    s_waitcnt lgkmcnt(8)
    v_mfma_f32_32x32x16_bf16 v[128:143], v[176:179], v[64:67], v[128:143]
    buffer_load_dwordx4 v246, s[12:15], s29 offen offset:3072 lds
    ds_read_b64_tr_b16 v[200:201], v12 offset:30720
    ds_read_b64_tr_b16 v[202:203], v12 offset:31232
    v_mfma_f32_32x32x16_bf16 v[144:159], v[180:183], v[64:67], v[144:159]
    ds_read_b64_tr_b16 v[204:205], v13 offset:30720
    ds_read_b64_tr_b16 v[206:207], v13 offset:31232
    s_waitcnt vmcnt(12)
    ds_read_b128 v[80:83], v8 offset:4096
    ds_read_b128 v[84:87], v9 offset:4096
    ds_read_b128 v[88:91], v10 offset:4096
    ds_read_b128 v[92:95], v11 offset:4096
    s_waitcnt lgkmcnt(12)
    v_mfma_f32_32x32x16_bf16 v[128:143], v[184:187], v[68:71], v[128:143]
    s_waitcnt vmcnt(10)
    s_barrier
    ds_read_b64_tr_b16 v[208:209], v12 offset:0
    ds_read_b64_tr_b16 v[210:211], v12 offset:512
    v_mfma_f32_32x32x16_bf16 v[144:159], v[188:191], v[68:71], v[144:159]
    s_waitcnt lgkmcnt(2)
    s_add_u32 m0, s36, 16384
    s_add_u32 s37, s37, 172032
    s_cmp_eq_u32 s37, 1204224
    s_cselect_b32 s37, 0, s37
    buffer_load_dwordx4 v4, s[16:19], s37 offen offset:0 lds
    ds_read_b64_tr_b16 v[212:213], v13 offset:0
    ds_read_b64_tr_b16 v[214:215], v13 offset:512
    s_waitcnt lgkmcnt(12)
    v_mfma_f32_32x32x16_bf16 v[128:143], v[192:195], v[72:75], v[128:143]
    buffer_load_dwordx4 v5, s[16:19], s37 offen offset:1024 lds
    ds_read_b64_tr_b16 v[216:217], v12 offset:2048
    ds_read_b64_tr_b16 v[218:219], v12 offset:2560
    v_mfma_f32_32x32x16_bf16 v[144:159], v[196:199], v[72:75], v[144:159]
    s_add_u32 m0, s40, 4096
    s_nop 0
    buffer_load_dwordx4 v14, s[16:19], s39 offen lds
    ds_read_b64_tr_b16 v[220:221], v13 offset:2048
    ds_read_b64_tr_b16 v[222:223], v13 offset:2560
    s_waitcnt lgkmcnt(12)
    v_mfma_f32_32x32x16_bf16 v[128:143], v[200:203], v[76:79], v[128:143]
    s_add_u32 m0, s40, 5120
    s_add_u32 s39, s39, 172032
    s_cmp_eq_u32 s39, 1204224
    s_cselect_b32 s39, 0, s39
    buffer_load_dwordx4 v14, s[16:19], s39 offen lds
    ds_read_b64_tr_b16 v[176:177], v12 offset:4096
    ds_read_b64_tr_b16 v[178:179], v12 offset:4608
    v_mfma_f32_32x32x16_bf16 v[144:159], v[204:207], v[76:79], v[144:159]
    s_add_u32 m0, s40, 6144
    s_add_u32 s39, s39, 172032
    s_cmp_eq_u32 s39, 1204224
    s_cselect_b32 s39, 0, s39
    buffer_load_dwordx4 v14, s[16:19], s39 offen lds
    ds_read_b64_tr_b16 v[180:181], v13 offset:4096
    ds_read_b64_tr_b16 v[182:183], v13 offset:4608
    s_waitcnt lgkmcnt(8)
    v_mfma_f32_32x32x16_bf16 v[128:143], v[208:211], v[80:83], v[128:143]
    s_add_u32 m0, s40, 7168
    s_add_u32 s39, s39, 172032
    s_cmp_eq_u32 s39, 1204224
    s_cselect_b32 s39, 0, s39
    buffer_load_dwordx4 v14, s[16:19], s39 offen lds
    ds_read_b64_tr_b16 v[184:185], v12 offset:6144
    ds_read_b64_tr_b16 v[186:187], v12 offset:6656
    v_mfma_f32_32x32x16_bf16 v[144:159], v[212:215], v[80:83], v[144:159]
    ds_read_b64_tr_b16 v[188:189], v13 offset:6144
    ds_read_b64_tr_b16 v[190:191], v13 offset:6656
    s_waitcnt vmcnt(12)
    ds_read_b128 v[96:99], v8 offset:8192
    ds_read_b128 v[100:103], v9 offset:8192
    ds_read_b128 v[104:107], v10 offset:8192
    ds_read_b128 v[108:111], v11 offset:8192
    s_waitcnt lgkmcnt(12)
    v_mfma_f32_32x32x16_bf16 v[128:143], v[216:219], v[84:87], v[128:143]
    s_waitcnt vmcnt(10)
    s_barrier
    ds_read_b64_tr_b16 v[192:193], v12 offset:8192
    ds_read_b64_tr_b16 v[194:195], v12 offset:8704
    v_mfma_f32_32x32x16_bf16 v[144:159], v[220:223], v[84:87], v[144:159]
    s_waitcnt lgkmcnt(2)
    s_add_u32 m0, s40, 8192
    s_add_u32 s39, s39, 172032
    s_cmp_eq_u32 s39, 1204224
    s_cselect_b32 s39, 0, s39
    buffer_load_dwordx4 v14, s[16:19], s39 offen lds
    ds_read_b64_tr_b16 v[196:197], v13 offset:8192
    ds_read_b64_tr_b16 v[198:199], v13 offset:8704
    s_waitcnt lgkmcnt(12)
    v_mfma_f32_32x32x16_bf16 v[128:143], v[176:179], v[88:91], v[128:143]
    s_add_u32 m0, s40, 9216
    s_add_u32 s39, s39, 172032
    s_cmp_eq_u32 s39, 1204224
    s_cselect_b32 s39, 0, s39
    buffer_load_dwordx4 v14, s[16:19], s39 offen lds
    ds_read_b64_tr_b16 v[200:201], v12 offset:10240
    ds_read_b64_tr_b16 v[202:203], v12 offset:10752
    v_mfma_f32_32x32x16_bf16 v[144:159], v[180:183], v[88:91], v[144:159]
    s_add_u32 m0, s40, 10240
    s_add_u32 s39, s39, 172032
    s_cmp_eq_u32 s39, 1204224
    s_cselect_b32 s39, 0, s39
    buffer_load_dwordx4 v14, s[16:19], s39 offen lds
    ds_read_b64_tr_b16 v[204:205], v13 offset:10240
    ds_read_b64_tr_b16 v[206:207], v13 offset:10752
    s_waitcnt lgkmcnt(12)
    v_mfma_f32_32x32x16_bf16 v[128:143], v[184:187], v[92:95], v[128:143]
    ds_read_b64_tr_b16 v[208:209], v12 offset:12288
    ds_read_b64_tr_b16 v[210:211], v12 offset:12800
    v_mfma_f32_32x32x16_bf16 v[144:159], v[188:191], v[92:95], v[144:159]
    ds_read_b64_tr_b16 v[212:213], v13 offset:12288
    ds_read_b64_tr_b16 v[214:215], v13 offset:12800
    s_waitcnt lgkmcnt(8)
    v_mfma_f32_32x32x16_bf16 v[128:143], v[192:195], v[96:99], v[128:143]
    ds_read_b64_tr_b16 v[216:217], v12 offset:14336
    ds_read_b64_tr_b16 v[218:219], v12 offset:14848
    v_mfma_f32_32x32x16_bf16 v[144:159], v[196:199], v[96:99], v[144:159]
    ds_read_b64_tr_b16 v[220:221], v13 offset:14336
    ds_read_b64_tr_b16 v[222:223], v13 offset:14848
    s_waitcnt vmcnt(9)
    ds_read_b128 v[112:115], v8 offset:0
    ds_read_b128 v[116:119], v9 offset:0
    ds_read_b128 v[120:123], v10 offset:0
    ds_read_b128 v[124:127], v11 offset:0
    s_waitcnt lgkmcnt(12)
    v_mfma_f32_32x32x16_bf16 v[128:143], v[200:203], v[100:103], v[128:143]
    s_waitcnt vmcnt(7)
    s_barrier
    ds_read_b64_tr_b16 v[176:177], v12 offset:16384
    ds_read_b64_tr_b16 v[178:179], v12 offset:16896
    v_mfma_f32_32x32x16_bf16 v[144:159], v[204:207], v[100:103], v[144:159]
    s_waitcnt lgkmcnt(2)
    ds_read_b64_tr_b16 v[180:181], v13 offset:16384
    ds_read_b64_tr_b16 v[182:183], v13 offset:16896
    s_waitcnt lgkmcnt(12)
    v_mfma_f32_32x32x16_bf16 v[128:143], v[208:211], v[104:107], v[128:143]
    ds_read_b64_tr_b16 v[184:185], v12 offset:18432
    ds_read_b64_tr_b16 v[186:187], v12 offset:18944
    v_mfma_f32_32x32x16_bf16 v[144:159], v[212:215], v[104:107], v[144:159]
    ds_read_b64_tr_b16 v[188:189], v13 offset:18432
    ds_read_b64_tr_b16 v[190:191], v13 offset:18944
    s_waitcnt lgkmcnt(12)
    v_mfma_f32_32x32x16_bf16 v[128:143], v[216:219], v[108:111], v[128:143]
    ds_read_b64_tr_b16 v[192:193], v12 offset:20480
    ds_read_b64_tr_b16 v[194:195], v12 offset:20992
    v_mfma_f32_32x32x16_bf16 v[144:159], v[220:223], v[108:111], v[144:159]
    ds_read_b64_tr_b16 v[196:197], v13 offset:20480
    ds_read_b64_tr_b16 v[198:199], v13 offset:20992
    s_waitcnt lgkmcnt(8)
    v_mfma_f32_32x32x16_bf16 v[128:143], v[176:179], v[112:115], v[128:143]
    ds_read_b64_tr_b16 v[200:201], v12 offset:22528
    ds_read_b64_tr_b16 v[202:203], v12 offset:23040
    v_mfma_f32_32x32x16_bf16 v[144:159], v[180:183], v[112:115], v[144:159]
    ds_read_b64_tr_b16 v[204:205], v13 offset:22528
    ds_read_b64_tr_b16 v[206:207], v13 offset:23040
    s_waitcnt lgkmcnt(8)
    v_mfma_f32_32x32x16_bf16 v[128:143], v[184:187], v[116:119], v[128:143]
    v_mfma_f32_32x32x16_bf16 v[144:159], v[188:191], v[116:119], v[144:159]
    s_waitcnt lgkmcnt(4)
    v_mfma_f32_32x32x16_bf16 v[128:143], v[192:195], v[120:123], v[128:143]
    v_mfma_f32_32x32x16_bf16 v[144:159], v[196:199], v[120:123], v[144:159]
    s_waitcnt lgkmcnt(0)
    v_mfma_f32_32x32x16_bf16 v[128:143], v[200:203], v[124:127], v[128:143]
    v_mfma_f32_32x32x16_bf16 v[144:159], v[204:207], v[124:127], v[144:159]
    s_branch A_ST
A_V:
    v_lshrrev_b32 v247, 5, v1
    v_mul_u32_u24 v247, 7552, v247
    v_add_u32 v247, v247, v2
    s_mul_i32 s38, s35, 32256
    s_mul_i32 s33, s55, 1152
    s_add_u32 s38, s38, s33
    s_add_u32 s38, s38, 2097152
    s_add_u32 s41, s38, 16128
    s_add_u32 s43, s38, 512
    s_add_u32 s44, s41, 512
    v_lshrrev_b32 v240, 1, v1
    v_mul_u32_u24 v240, 8064, v240
    v_and_b32 v241, 1, v1
    v_lshl_add_u32 v240, v241, 4, v240
    v_subrev_u32 v241, 1, v241
    v_and_b32 v224, 0x3f803f80, v241
    v_and_b32 v225, 0x3f803f80, v241
    v_and_b32 v226, 0x3f803f80, v241
    v_and_b32 v227, 0x3f803f80, v241
    s_mov_b64 exec, 0xff
    buffer_store_dwordx4 v[224:227], v240, s[20:23], s38 offen offset:1024 sc1
    s_mov_b64 exec, -1
    buffer_load_dwordx4 v245, s[12:15], s29 offen offset:2048 lds
    buffer_load_dwordx4 v246, s[12:15], s29 offen offset:3072 lds
    s_add_u32 m0, s36, 8192
    s_add_u32 s37, s37, 172032
    s_cmp_eq_u32 s37, 1204224
    s_cselect_b32 s37, 0, s37
    buffer_load_dwordx4 v4, s[16:19], s37 offen offset:0 lds
    buffer_load_dwordx4 v5, s[16:19], s37 offen offset:1024 lds
    s_add_u32 m0, s40, 8192
    s_add_u32 s29, s29, 128
    s_cmp_eq_u32 s29, 896
    s_cselect_b32 s29, 0, s29
    buffer_load_dwordx4 v3, s[12:15], s29 offen offset:0 lds
    buffer_load_dwordx4 v244, s[12:15], s29 offen offset:1024 lds
    buffer_load_dwordx4 v245, s[12:15], s29 offen offset:2048 lds
    buffer_load_dwordx4 v246, s[12:15], s29 offen offset:3072 lds
    s_waitcnt vmcnt(20)
    ds_read_b128 v[16:19], v8 offset:0
    ds_read_b128 v[20:23], v9 offset:0
    ds_read_b128 v[24:27], v10 offset:0
    ds_read_b128 v[28:31], v11 offset:0
    s_add_u32 m0, s36, 16384
    s_add_u32 s37, s37, 172032
    s_cmp_eq_u32 s37, 1204224
    s_cselect_b32 s37, 0, s37
    buffer_load_dwordx4 v4, s[16:19], s37 offen offset:0 lds
    s_waitcnt vmcnt(19)
    s_barrier
    s_cmp_lg_u32 s24, 0
    s_cbranch_scc1 NI3
    global_load_dword v248, v255, s[92:93] sc1
NI3:
    ds_read_b64_tr_b16 v[176:177], v12 offset:0
    ds_read_b64_tr_b16 v[178:179], v12 offset:512
    s_waitcnt lgkmcnt(2)
    buffer_load_dwordx4 v5, s[16:19], s37 offen offset:1024 lds
    ds_read_b64_tr_b16 v[180:181], v13 offset:0
    ds_read_b64_tr_b16 v[182:183], v13 offset:512
    s_add_u32 m0, s40, 0
    s_add_u32 s29, s29, 128
    s_cmp_eq_u32 s29, 896
    s_cselect_b32 s29, 0, s29
    buffer_load_dwordx4 v3, s[12:15], s29 offen offset:0 lds
    ds_read_b64_tr_b16 v[184:185], v12 offset:2048
    ds_read_b64_tr_b16 v[186:187], v12 offset:2560
    buffer_load_dwordx4 v244, s[12:15], s29 offen offset:1024 lds
    ds_read_b64_tr_b16 v[188:189], v13 offset:2048
    ds_read_b64_tr_b16 v[190:191], v13 offset:2560
    s_waitcnt vmcnt(12)
    s_mov_b32 exec_hi, 0xffffff
    v_perm_b32 v136, v129, v128, s50
    v_perm_b32 v137, v131, v130, s50
    v_perm_b32 v138, v133, v132, s50
    v_perm_b32 v139, v135, v134, s50
    buffer_store_dwordx4 v[136:139], v2, s[20:23], s48 offen offset:0 sc1
    v_perm_b32 v140, v129, v128, s51
    v_perm_b32 v141, v131, v130, s51
    v_perm_b32 v142, v133, v132, s51
    v_perm_b32 v143, v135, v134, s51
    buffer_store_dwordx4 v[140:143], v2, s[20:23], s48 offen offset:3584 sc1
    s_mov_b64 exec, -1
    buffer_load_dwordx4 v245, s[12:15], s29 offen offset:2048 lds
    ds_read_b64_tr_b16 v[192:193], v12 offset:4096
    ds_read_b64_tr_b16 v[194:195], v12 offset:4608
    buffer_load_dwordx4 v246, s[12:15], s29 offen offset:3072 lds
    ds_read_b64_tr_b16 v[196:197], v13 offset:4096
    ds_read_b64_tr_b16 v[198:199], v13 offset:4608
    s_waitcnt lgkmcnt(8)
    v_mfma_f32_32x32x16_bf16 v[128:143], v[16:19], v[176:179], 0
    s_add_u32 m0, s36, 24576
    s_add_u32 s37, s37, 172032
    s_cmp_eq_u32 s37, 1204224
    s_cselect_b32 s37, 0, s37
    buffer_load_dwordx4 v4, s[16:19], s37 offen offset:0 lds
    ds_read_b64_tr_b16 v[200:201], v12 offset:6144
    ds_read_b64_tr_b16 v[202:203], v12 offset:6656
    v_mfma_f32_32x32x16_bf16 v[144:159], v[16:19], v[180:183], 0
    buffer_load_dwordx4 v5, s[16:19], s37 offen offset:1024 lds
    ds_read_b64_tr_b16 v[204:205], v13 offset:6144
    ds_read_b64_tr_b16 v[206:207], v13 offset:6656
    s_waitcnt vmcnt(16)
    ds_read_b128 v[32:35], v8 offset:4096
    ds_read_b128 v[36:39], v9 offset:4096
    ds_read_b128 v[40:43], v10 offset:4096
    ds_read_b128 v[44:47], v11 offset:4096
    s_waitcnt lgkmcnt(12)
    v_mfma_f32_32x32x16_bf16 v[128:143], v[20:23], v[184:187], v[128:143]
    s_waitcnt vmcnt(14)
    s_barrier
    ds_read_b64_tr_b16 v[208:209], v12 offset:8192
    ds_read_b64_tr_b16 v[210:211], v12 offset:8704
    v_mfma_f32_32x32x16_bf16 v[144:159], v[20:23], v[188:191], v[144:159]
    s_waitcnt lgkmcnt(2)
    s_add_u32 m0, s40, 4096
    s_add_u32 s29, s29, 128
    s_cmp_eq_u32 s29, 896
    s_cselect_b32 s29, 0, s29
    buffer_load_dwordx4 v3, s[12:15], s29 offen offset:0 lds
    ds_read_b64_tr_b16 v[212:213], v13 offset:8192
    ds_read_b64_tr_b16 v[214:215], v13 offset:8704
    s_waitcnt lgkmcnt(12)
    v_mfma_f32_32x32x16_bf16 v[128:143], v[24:27], v[192:195], v[128:143]
    buffer_load_dwordx4 v244, s[12:15], s29 offen offset:1024 lds
    ds_read_b64_tr_b16 v[216:217], v12 offset:10240
    ds_read_b64_tr_b16 v[218:219], v12 offset:10752
    v_mfma_f32_32x32x16_bf16 v[144:159], v[24:27], v[196:199], v[144:159]
    buffer_load_dwordx4 v245, s[12:15], s29 offen offset:2048 lds
    ds_read_b64_tr_b16 v[220:221], v13 offset:10240
    ds_read_b64_tr_b16 v[222:223], v13 offset:10752
    s_waitcnt lgkmcnt(12)
    v_mfma_f32_32x32x16_bf16 v[128:143], v[28:31], v[200:203], v[128:143]
    buffer_load_dwordx4 v246, s[12:15], s29 offen offset:3072 lds
    ds_read_b64_tr_b16 v[176:177], v12 offset:12288
    ds_read_b64_tr_b16 v[178:179], v12 offset:12800
    v_mfma_f32_32x32x16_bf16 v[144:159], v[28:31], v[204:207], v[144:159]
    ds_read_b64_tr_b16 v[180:181], v13 offset:12288
    ds_read_b64_tr_b16 v[182:183], v13 offset:12800
    s_waitcnt lgkmcnt(8)
    v_mfma_f32_32x32x16_bf16 v[128:143], v[32:35], v[208:211], v[128:143]
    ds_read_b64_tr_b16 v[184:185], v12 offset:14336
    ds_read_b64_tr_b16 v[186:187], v12 offset:14848
    v_mfma_f32_32x32x16_bf16 v[144:159], v[32:35], v[212:215], v[144:159]
    ds_read_b64_tr_b16 v[188:189], v13 offset:14336
    ds_read_b64_tr_b16 v[190:191], v13 offset:14848
    s_waitcnt vmcnt(14)
    ds_read_b128 v[48:51], v8 offset:8192
    ds_read_b128 v[52:55], v9 offset:8192
    ds_read_b128 v[56:59], v10 offset:8192
    ds_read_b128 v[60:63], v11 offset:8192
    s_waitcnt lgkmcnt(12)
    v_mfma_f32_32x32x16_bf16 v[128:143], v[36:39], v[216:219], v[128:143]
    s_waitcnt vmcnt(12)
    s_barrier
    ds_read_b64_tr_b16 v[192:193], v12 offset:16384
    ds_read_b64_tr_b16 v[194:195], v12 offset:16896
    v_mfma_f32_32x32x16_bf16 v[144:159], v[36:39], v[220:223], v[144:159]
    s_waitcnt lgkmcnt(2)
    s_add_u32 m0, s36, 0
    s_add_u32 s37, s37, 172032
    s_cmp_eq_u32 s37, 1204224
    s_cselect_b32 s37, 0, s37
    buffer_load_dwordx4 v4, s[16:19], s37 offen offset:0 lds
    ds_read_b64_tr_b16 v[196:197], v13 offset:16384
    ds_read_b64_tr_b16 v[198:199], v13 offset:16896
    s_waitcnt lgkmcnt(12)
    v_mfma_f32_32x32x16_bf16 v[128:143], v[40:43], v[176:179], v[128:143]
    buffer_load_dwordx4 v5, s[16:19], s37 offen offset:1024 lds
    ds_read_b64_tr_b16 v[200:201], v12 offset:18432
    ds_read_b64_tr_b16 v[202:203], v12 offset:18944
    v_mfma_f32_32x32x16_bf16 v[144:159], v[40:43], v[180:183], v[144:159]
    s_add_u32 m0, s40, 8192
    s_add_u32 s29, s29, 128
    s_cmp_eq_u32 s29, 896
    s_cselect_b32 s29, 0, s29
    buffer_load_dwordx4 v3, s[12:15], s29 offen offset:0 lds
    ds_read_b64_tr_b16 v[204:205], v13 offset:18432
    ds_read_b64_tr_b16 v[206:207], v13 offset:18944
    s_waitcnt lgkmcnt(12)
    v_mfma_f32_32x32x16_bf16 v[128:143], v[44:47], v[184:187], v[128:143]
    buffer_load_dwordx4 v244, s[12:15], s29 offen offset:1024 lds
    ds_read_b64_tr_b16 v[208:209], v12 offset:20480
    ds_read_b64_tr_b16 v[210:211], v12 offset:20992
    v_mfma_f32_32x32x16_bf16 v[144:159], v[44:47], v[188:191], v[144:159]
    buffer_load_dwordx4 v245, s[12:15], s29 offen offset:2048 lds
    ds_read_b64_tr_b16 v[212:213], v13 offset:20480
    ds_read_b64_tr_b16 v[214:215], v13 offset:20992
    s_waitcnt lgkmcnt(8)
    v_mfma_f32_32x32x16_bf16 v[128:143], v[48:51], v[192:195], v[128:143]
    buffer_load_dwordx4 v246, s[12:15], s29 offen offset:3072 lds
    ds_read_b64_tr_b16 v[216:217], v12 offset:22528
    ds_read_b64_tr_b16 v[218:219], v12 offset:23040
    v_mfma_f32_32x32x16_bf16 v[144:159], v[48:51], v[196:199], v[144:159]
    ds_read_b64_tr_b16 v[220:221], v13 offset:22528
    ds_read_b64_tr_b16 v[222:223], v13 offset:23040
    s_waitcnt vmcnt(12)
    ds_read_b128 v[64:67], v8 offset:0
    ds_read_b128 v[68:71], v9 offset:0
    ds_read_b128 v[72:75], v10 offset:0
    ds_read_b128 v[76:79], v11 offset:0
    s_waitcnt lgkmcnt(12)
    v_mfma_f32_32x32x16_bf16 v[128:143], v[52:55], v[200:203], v[128:143]
    s_waitcnt vmcnt(10)
    s_barrier
    s_cmp_lg_u32 s24, 0
    s_cbranch_scc1 ND4
    s_mov_b32 s62, 40000
NT4:
    v_readfirstlane_b32 s60, v248
    s_nop 1
    s_cmp_ge_u32 s60, 8
    s_cbranch_scc1 ND4
    s_sub_u32 s62, s62, 1
    s_cbranch_scc1 ND4
    s_sleep 8
    global_load_dword v248, v255, s[92:93] sc1
    s_waitcnt vmcnt(0)
    s_branch NT4
ND4:
    s_cmp_lg_u32 s24, 0
    s_cbranch_scc1 XPV
    v_mov_b32 v249, 1
    s_mov_b64 exec, 0xff
    buffer_atomic_add v249, v7, s[20:23], s49 offen sc1
    s_mov_b64 exec, -1
XPV:
    ds_read_b64_tr_b16 v[176:177], v12 offset:24576
    ds_read_b64_tr_b16 v[178:179], v12 offset:25088
    v_mfma_f32_32x32x16_bf16 v[144:159], v[52:55], v[204:207], v[144:159]
    s_waitcnt lgkmcnt(2)
    s_add_u32 m0, s36, 8192
    s_add_u32 s37, s37, 172032
    s_cmp_eq_u32 s37, 1204224
    s_cselect_b32 s37, 0, s37
    buffer_load_dwordx4 v4, s[16:19], s37 offen offset:0 lds
    ds_read_b64_tr_b16 v[180:181], v13 offset:24576
    ds_read_b64_tr_b16 v[182:183], v13 offset:25088
    s_waitcnt lgkmcnt(12)
    v_mfma_f32_32x32x16_bf16 v[128:143], v[56:59], v[208:211], v[128:143]
    buffer_load_dwordx4 v5, s[16:19], s37 offen offset:1024 lds
    ds_read_b64_tr_b16 v[184:185], v12 offset:26624
    ds_read_b64_tr_b16 v[186:187], v12 offset:27136
    v_mfma_f32_32x32x16_bf16 v[144:159], v[56:59], v[212:215], v[144:159]
    s_add_u32 m0, s40, 0
    s_add_u32 s29, s29, 128
    s_cmp_eq_u32 s29, 896
    s_cselect_b32 s29, 0, s29
    buffer_load_dwordx4 v3, s[12:15], s29 offen offset:0 lds
    ds_read_b64_tr_b16 v[188:189], v13 offset:26624
    ds_read_b64_tr_b16 v[190:191], v13 offset:27136
    s_waitcnt lgkmcnt(12)
    v_mfma_f32_32x32x16_bf16 v[128:143], v[60:63], v[216:219], v[128:143]
    buffer_load_dwordx4 v244, s[12:15], s29 offen offset:1024 lds
    ds_read_b64_tr_b16 v[192:193], v12 offset:28672
    ds_read_b64_tr_b16 v[194:195], v12 offset:29184
    v_mfma_f32_32x32x16_bf16 v[144:159], v[60:63], v[220:223], v[144:159]
    buffer_load_dwordx4 v245, s[12:15], s29 offen offset:2048 lds
    ds_read_b64_tr_b16 v[196:197], v13 offset:28672
    ds_read_b64_tr_b16 v[198:199], v13 offset:29184
    s_waitcnt lgkmcnt(8)
    v_mfma_f32_32x32x16_bf16 v[128:143], v[64:67], v[176:179], v[128:143]
    buffer_load_dwordx4 v246, s[12:15], s29 offen offset:3072 lds
    ds_read_b64_tr_b16 v[200:201], v12 offset:30720
    ds_read_b64_tr_b16 v[202:203], v12 offset:31232
    v_mfma_f32_32x32x16_bf16 v[144:159], v[64:67], v[180:183], v[144:159]
    ds_read_b64_tr_b16 v[204:205], v13 offset:30720
    ds_read_b64_tr_b16 v[206:207], v13 offset:31232
    s_waitcnt vmcnt(12)
    ds_read_b128 v[80:83], v8 offset:4096
    ds_read_b128 v[84:87], v9 offset:4096
    ds_read_b128 v[88:91], v10 offset:4096
    ds_read_b128 v[92:95], v11 offset:4096
    s_waitcnt lgkmcnt(12)
    v_mfma_f32_32x32x16_bf16 v[128:143], v[68:71], v[184:187], v[128:143]
    s_waitcnt vmcnt(10)
    s_barrier
    ds_read_b64_tr_b16 v[208:209], v12 offset:0
    ds_read_b64_tr_b16 v[210:211], v12 offset:512
    v_mfma_f32_32x32x16_bf16 v[144:159], v[68:71], v[188:191], v[144:159]
    s_waitcnt lgkmcnt(2)
    s_add_u32 m0, s36, 16384
    s_add_u32 s37, s37, 172032
    s_cmp_eq_u32 s37, 1204224
    s_cselect_b32 s37, 0, s37
    buffer_load_dwordx4 v4, s[16:19], s37 offen offset:0 lds
    ds_read_b64_tr_b16 v[212:213], v13 offset:0
    ds_read_b64_tr_b16 v[214:215], v13 offset:512
    s_waitcnt lgkmcnt(12)
    v_mfma_f32_32x32x16_bf16 v[128:143], v[72:75], v[192:195], v[128:143]
    buffer_load_dwordx4 v5, s[16:19], s37 offen offset:1024 lds
    ds_read_b64_tr_b16 v[216:217], v12 offset:2048
    ds_read_b64_tr_b16 v[218:219], v12 offset:2560
    v_mfma_f32_32x32x16_bf16 v[144:159], v[72:75], v[196:199], v[144:159]
    s_add_u32 m0, s40, 4096
    s_nop 0
    buffer_load_dwordx4 v14, s[16:19], s39 offen lds
    ds_read_b64_tr_b16 v[220:221], v13 offset:2048
    ds_read_b64_tr_b16 v[222:223], v13 offset:2560
    s_waitcnt lgkmcnt(12)
    v_mfma_f32_32x32x16_bf16 v[128:143], v[76:79], v[200:203], v[128:143]
    s_add_u32 m0, s40, 5120
    s_add_u32 s39, s39, 172032
    s_cmp_eq_u32 s39, 1204224
    s_cselect_b32 s39, 0, s39
    buffer_load_dwordx4 v14, s[16:19], s39 offen lds
    ds_read_b64_tr_b16 v[176:177], v12 offset:4096
    ds_read_b64_tr_b16 v[178:179], v12 offset:4608
    v_mfma_f32_32x32x16_bf16 v[144:159], v[76:79], v[204:207], v[144:159]
    s_add_u32 m0, s40, 6144
    s_add_u32 s39, s39, 172032
    s_cmp_eq_u32 s39, 1204224
    s_cselect_b32 s39, 0, s39
    buffer_load_dwordx4 v14, s[16:19], s39 offen lds
    ds_read_b64_tr_b16 v[180:181], v13 offset:4096
    ds_read_b64_tr_b16 v[182:183], v13 offset:4608
    s_waitcnt lgkmcnt(8)
    v_mfma_f32_32x32x16_bf16 v[128:143], v[80:83], v[208:211], v[128:143]
    s_add_u32 m0, s40, 7168
    s_add_u32 s39, s39, 172032
    s_cmp_eq_u32 s39, 1204224
    s_cselect_b32 s39, 0, s39
    buffer_load_dwordx4 v14, s[16:19], s39 offen lds
    ds_read_b64_tr_b16 v[184:185], v12 offset:6144
    ds_read_b64_tr_b16 v[186:187], v12 offset:6656
    v_mfma_f32_32x32x16_bf16 v[144:159], v[80:83], v[212:215], v[144:159]
    ds_read_b64_tr_b16 v[188:189], v13 offset:6144
    ds_read_b64_tr_b16 v[190:191], v13 offset:6656
    s_waitcnt vmcnt(12)
    ds_read_b128 v[96:99], v8 offset:8192
    ds_read_b128 v[100:103], v9 offset:8192
    ds_read_b128 v[104:107], v10 offset:8192
    ds_read_b128 v[108:111], v11 offset:8192
    s_waitcnt lgkmcnt(12)
    v_mfma_f32_32x32x16_bf16 v[128:143], v[84:87], v[216:219], v[128:143]
    s_waitcnt vmcnt(10)
    s_barrier
    ds_read_b64_tr_b16 v[192:193], v12 offset:8192
    ds_read_b64_tr_b16 v[194:195], v12 offset:8704
    v_mfma_f32_32x32x16_bf16 v[144:159], v[84:87], v[220:223], v[144:159]
    s_waitcnt lgkmcnt(2)
    s_add_u32 m0, s40, 8192
    s_add_u32 s39, s39, 172032
    s_cmp_eq_u32 s39, 1204224
    s_cselect_b32 s39, 0, s39
    buffer_load_dwordx4 v14, s[16:19], s39 offen lds
    ds_read_b64_tr_b16 v[196:197], v13 offset:8192
    ds_read_b64_tr_b16 v[198:199], v13 offset:8704
    s_waitcnt lgkmcnt(12)
    v_mfma_f32_32x32x16_bf16 v[128:143], v[88:91], v[176:179], v[128:143]
    s_add_u32 m0, s40, 9216
    s_add_u32 s39, s39, 172032
    s_cmp_eq_u32 s39, 1204224
    s_cselect_b32 s39, 0, s39
    buffer_load_dwordx4 v14, s[16:19], s39 offen lds
    ds_read_b64_tr_b16 v[200:201], v12 offset:10240
    ds_read_b64_tr_b16 v[202:203], v12 offset:10752
    v_mfma_f32_32x32x16_bf16 v[144:159], v[88:91], v[180:183], v[144:159]
    s_add_u32 m0, s40, 10240
    s_add_u32 s39, s39, 172032
    s_cmp_eq_u32 s39, 1204224
    s_cselect_b32 s39, 0, s39
    buffer_load_dwordx4 v14, s[16:19], s39 offen lds
    ds_read_b64_tr_b16 v[204:205], v13 offset:10240
    ds_read_b64_tr_b16 v[206:207], v13 offset:10752
    s_waitcnt lgkmcnt(12)
    v_mfma_f32_32x32x16_bf16 v[128:143], v[92:95], v[184:187], v[128:143]
    ds_read_b64_tr_b16 v[208:209], v12 offset:12288
    ds_read_b64_tr_b16 v[210:211], v12 offset:12800
    v_mfma_f32_32x32x16_bf16 v[144:159], v[92:95], v[188:191], v[144:159]
    ds_read_b64_tr_b16 v[212:213], v13 offset:12288
    ds_read_b64_tr_b16 v[214:215], v13 offset:12800
    s_waitcnt lgkmcnt(8)
    v_mfma_f32_32x32x16_bf16 v[128:143], v[96:99], v[192:195], v[128:143]
    ds_read_b64_tr_b16 v[216:217], v12 offset:14336
    ds_read_b64_tr_b16 v[218:219], v12 offset:14848
    v_mfma_f32_32x32x16_bf16 v[144:159], v[96:99], v[196:199], v[144:159]
    ds_read_b64_tr_b16 v[220:221], v13 offset:14336
    ds_read_b64_tr_b16 v[222:223], v13 offset:14848
    s_waitcnt vmcnt(9)
    ds_read_b128 v[112:115], v8 offset:0
    ds_read_b128 v[116:119], v9 offset:0
    ds_read_b128 v[120:123], v10 offset:0
    ds_read_b128 v[124:127], v11 offset:0
    s_waitcnt lgkmcnt(12)
    v_mfma_f32_32x32x16_bf16 v[128:143], v[100:103], v[200:203], v[128:143]
    s_waitcnt vmcnt(7)
    s_barrier
    ds_read_b64_tr_b16 v[176:177], v12 offset:16384
    ds_read_b64_tr_b16 v[178:179], v12 offset:16896
    v_mfma_f32_32x32x16_bf16 v[144:159], v[100:103], v[204:207], v[144:159]
    s_waitcnt lgkmcnt(2)
    ds_read_b64_tr_b16 v[180:181], v13 offset:16384
    ds_read_b64_tr_b16 v[182:183], v13 offset:16896
    s_waitcnt lgkmcnt(12)
    v_mfma_f32_32x32x16_bf16 v[128:143], v[104:107], v[208:211], v[128:143]
    ds_read_b64_tr_b16 v[184:185], v12 offset:18432
    ds_read_b64_tr_b16 v[186:187], v12 offset:18944
    v_mfma_f32_32x32x16_bf16 v[144:159], v[104:107], v[212:215], v[144:159]
    ds_read_b64_tr_b16 v[188:189], v13 offset:18432
    ds_read_b64_tr_b16 v[190:191], v13 offset:18944
    s_waitcnt lgkmcnt(12)
    v_mfma_f32_32x32x16_bf16 v[128:143], v[108:111], v[216:219], v[128:143]
    ds_read_b64_tr_b16 v[192:193], v12 offset:20480
    ds_read_b64_tr_b16 v[194:195], v12 offset:20992
    v_mfma_f32_32x32x16_bf16 v[144:159], v[108:111], v[220:223], v[144:159]
    ds_read_b64_tr_b16 v[196:197], v13 offset:20480
    ds_read_b64_tr_b16 v[198:199], v13 offset:20992
    s_waitcnt lgkmcnt(8)
    v_mfma_f32_32x32x16_bf16 v[128:143], v[112:115], v[176:179], v[128:143]
    ds_read_b64_tr_b16 v[200:201], v12 offset:22528
    ds_read_b64_tr_b16 v[202:203], v12 offset:23040
    v_mfma_f32_32x32x16_bf16 v[144:159], v[112:115], v[180:183], v[144:159]
    ds_read_b64_tr_b16 v[204:205], v13 offset:22528
    ds_read_b64_tr_b16 v[206:207], v13 offset:23040
    s_waitcnt lgkmcnt(8)
    v_mfma_f32_32x32x16_bf16 v[128:143], v[116:119], v[184:187], v[128:143]
    v_mfma_f32_32x32x16_bf16 v[144:159], v[116:119], v[188:191], v[144:159]
    s_waitcnt lgkmcnt(4)
    v_mfma_f32_32x32x16_bf16 v[128:143], v[120:123], v[192:195], v[128:143]
    v_mfma_f32_32x32x16_bf16 v[144:159], v[120:123], v[196:199], v[144:159]
    s_waitcnt lgkmcnt(0)
    v_mfma_f32_32x32x16_bf16 v[128:143], v[124:127], v[200:203], v[128:143]
    v_mfma_f32_32x32x16_bf16 v[144:159], v[124:127], v[204:207], v[144:159]
A_ST:
    s_nop 10
    v_cvt_pk_bf16_f32 v224, v128, v129
    v_cvt_pk_bf16_f32 v225, v130, v131
    v_cvt_pk_bf16_f32 v226, v132, v133
    v_cvt_pk_bf16_f32 v227, v134, v135
    v_cvt_pk_bf16_f32 v228, v136, v137
    v_cvt_pk_bf16_f32 v229, v138, v139
    v_cvt_pk_bf16_f32 v230, v140, v141
    v_cvt_pk_bf16_f32 v231, v142, v143
    buffer_store_dwordx4 v[224:227], v247, s[20:23], s38 offen sc1
    buffer_store_dwordx4 v[228:231], v247, s[20:23], s41 offen sc1
    v_cvt_pk_bf16_f32 v232, v144, v145
    v_cvt_pk_bf16_f32 v233, v146, v147
    v_cvt_pk_bf16_f32 v234, v148, v149
    v_cvt_pk_bf16_f32 v235, v150, v151
    v_cvt_pk_bf16_f32 v236, v152, v153
    v_cvt_pk_bf16_f32 v237, v154, v155
    v_cvt_pk_bf16_f32 v238, v156, v157
    v_cvt_pk_bf16_f32 v239, v158, v159
    buffer_store_dwordx4 v[232:235], v247, s[20:23], s43 offen sc1
    buffer_store_dwordx4 v[236:239], v247, s[20:23], s44 offen sc1
    s_waitcnt vmcnt(4)
    s_branch A_P2
A_GOL:
    s_lshl_b32 s36, s24, 13
    s_add_u32 m0, s40, 0
    s_nop 0
    buffer_load_dwordx4 v3, s[12:15], s29 offen offset:0 lds
    buffer_load_dwordx4 v244, s[12:15], s29 offen offset:1024 lds
    buffer_load_dwordx4 v245, s[12:15], s29 offen offset:2048 lds
    buffer_load_dwordx4 v246, s[12:15], s29 offen offset:3072 lds
    s_add_u32 m0, s40, 4096
    s_add_u32 s29, s29, 128
    s_cmp_eq_u32 s29, 896
    s_cselect_b32 s29, 0, s29
    buffer_load_dwordx4 v3, s[12:15], s29 offen offset:0 lds
    buffer_load_dwordx4 v244, s[12:15], s29 offen offset:1024 lds
    buffer_load_dwordx4 v245, s[12:15], s29 offen offset:2048 lds
    buffer_load_dwordx4 v246, s[12:15], s29 offen offset:3072 lds
    s_branch A_GO
A_LIGHT:
    s_add_u32 m0, s40, 8192
    s_add_u32 s29, s29, 128
    s_cmp_eq_u32 s29, 896
    s_cselect_b32 s29, 0, s29
    buffer_load_dwordx4 v3, s[12:15], s29 offen offset:0 lds
    buffer_load_dwordx4 v244, s[12:15], s29 offen offset:1024 lds
    buffer_load_dwordx4 v245, s[12:15], s29 offen offset:2048 lds
    buffer_load_dwordx4 v246, s[12:15], s29 offen offset:3072 lds
    s_waitcnt vmcnt(4)
    s_mov_b32 exec_hi, 0xffffff
    v_perm_b32 v136, v129, v128, s50
    v_perm_b32 v137, v131, v130, s50
    v_perm_b32 v138, v133, v132, s50
    v_perm_b32 v139, v135, v134, s50
    buffer_store_dwordx4 v[136:139], v2, s[20:23], s48 offen offset:0 sc1
    v_perm_b32 v140, v129, v128, s51
    v_perm_b32 v141, v131, v130, s51
    v_perm_b32 v142, v133, v132, s51
    v_perm_b32 v143, v135, v134, s51
    buffer_store_dwordx4 v[140:143], v2, s[20:23], s48 offen offset:3584 sc1
    s_mov_b64 exec, -1
    s_cmp_lg_u32 s24, 0
    s_cbranch_scc1 NI5
    global_load_dword v248, v255, s[92:93] sc1
NI5:
    s_add_u32 m0, s36, 0
    s_add_u32 s29, s29, 128
    s_cmp_eq_u32 s29, 896
    s_cselect_b32 s29, 0, s29
    buffer_load_dwordx4 v3, s[12:15], s29 offen offset:0 lds
    buffer_load_dwordx4 v244, s[12:15], s29 offen offset:1024 lds
    buffer_load_dwordx4 v245, s[12:15], s29 offen offset:2048 lds
    buffer_load_dwordx4 v246, s[12:15], s29 offen offset:3072 lds
    s_add_u32 m0, s36, 4096
    s_add_u32 s29, s29, 128
    s_cmp_eq_u32 s29, 896
    s_cselect_b32 s29, 0, s29
    buffer_load_dwordx4 v3, s[12:15], s29 offen offset:0 lds
    buffer_load_dwordx4 v244, s[12:15], s29 offen offset:1024 lds
    buffer_load_dwordx4 v245, s[12:15], s29 offen offset:2048 lds
    buffer_load_dwordx4 v246, s[12:15], s29 offen offset:3072 lds
    s_sub_u32 s33, s36, s40
    v_add_u32 v4, s33, v8
    v_add_u32 v5, s33, v9
    v_add_u32 v12, s33, v10
    v_add_u32 v13, s33, v11
    s_waitcnt vmcnt(26)
    ds_read_b128 v[16:19], v8 offset:0
    ds_read_b128 v[20:23], v9 offset:0
    ds_read_b128 v[24:27], v10 offset:0
    ds_read_b128 v[28:31], v11 offset:0
    s_waitcnt lgkmcnt(0)
    s_add_u32 m0, s40, 0
    s_add_u32 s29, s29, 128
    s_cmp_eq_u32 s29, 896
    s_cselect_b32 s29, 0, s29
    buffer_load_dwordx4 v3, s[12:15], s29 offen offset:0 lds
    buffer_load_dwordx4 v244, s[12:15], s29 offen offset:1024 lds
    buffer_load_dwordx4 v245, s[12:15], s29 offen offset:2048 lds
    buffer_load_dwordx4 v246, s[12:15], s29 offen offset:3072 lds
    s_waitcnt vmcnt(26)
    ds_read_b128 v[32:35], v8 offset:4096
    ds_read_b128 v[36:39], v9 offset:4096
    ds_read_b128 v[40:43], v10 offset:4096
    ds_read_b128 v[44:47], v11 offset:4096
    s_waitcnt lgkmcnt(0)
    s_add_u32 m0, s40, 4096
    s_nop 0
    buffer_load_dwordx4 v14, s[16:19], s39 offen lds
    s_add_u32 m0, s40, 5120
    s_add_u32 s39, s39, 172032
    s_cmp_eq_u32 s39, 1204224
    s_cselect_b32 s39, 0, s39
    buffer_load_dwordx4 v14, s[16:19], s39 offen lds
    s_add_u32 m0, s40, 6144
    s_add_u32 s39, s39, 172032
    s_cmp_eq_u32 s39, 1204224
    s_cselect_b32 s39, 0, s39
    buffer_load_dwordx4 v14, s[16:19], s39 offen lds
    s_add_u32 m0, s40, 7168
    s_add_u32 s39, s39, 172032
    s_cmp_eq_u32 s39, 1204224
    s_cselect_b32 s39, 0, s39
    buffer_load_dwordx4 v14, s[16:19], s39 offen lds
    s_waitcnt vmcnt(18)
    ds_read_b128 v[48:51], v8 offset:8192
    ds_read_b128 v[52:55], v9 offset:8192
    ds_read_b128 v[56:59], v10 offset:8192
    ds_read_b128 v[60:63], v11 offset:8192
    s_waitcnt lgkmcnt(0)
    s_add_u32 m0, s40, 8192
    s_add_u32 s39, s39, 172032
    s_cmp_eq_u32 s39, 1204224
    s_cselect_b32 s39, 0, s39
    buffer_load_dwordx4 v14, s[16:19], s39 offen lds
    s_add_u32 m0, s40, 9216
    s_add_u32 s39, s39, 172032
    s_cmp_eq_u32 s39, 1204224
    s_cselect_b32 s39, 0, s39
    buffer_load_dwordx4 v14, s[16:19], s39 offen lds
    s_add_u32 m0, s40, 10240
    s_add_u32 s39, s39, 172032
    s_cmp_eq_u32 s39, 1204224
    s_cselect_b32 s39, 0, s39
    buffer_load_dwordx4 v14, s[16:19], s39 offen lds
    s_waitcnt vmcnt(15)
    ds_read_b128 v[64:67], v4 offset:0
    ds_read_b128 v[68:71], v5 offset:0
    ds_read_b128 v[72:75], v12 offset:0
    ds_read_b128 v[76:79], v13 offset:0
    s_waitcnt lgkmcnt(0)
    s_add_u32 m0, s36, 0
    s_add_u32 s29, s29, 128
    s_cmp_eq_u32 s29, 896
    s_cselect_b32 s29, 0, s29
    buffer_load_dwordx4 v3, s[12:15], s29 offen offset:0 lds
    buffer_load_dwordx4 v244, s[12:15], s29 offen offset:1024 lds
    buffer_load_dwordx4 v245, s[12:15], s29 offen offset:2048 lds
    buffer_load_dwordx4 v246, s[12:15], s29 offen offset:3072 lds
    s_barrier
    s_cmp_lg_u32 s24, 0
    s_cbranch_scc1 ND6
    s_mov_b32 s62, 40000
NT6:
    v_readfirstlane_b32 s60, v248
    s_nop 1
    s_cmp_ge_u32 s60, 8
    s_cbranch_scc1 ND6
    s_sub_u32 s62, s62, 1
    s_cbranch_scc1 ND6
    s_sleep 8
    global_load_dword v248, v255, s[92:93] sc1
    s_waitcnt vmcnt(0)
    s_branch NT6
ND6:
    s_cmp_lg_u32 s24, 0
    s_cbranch_scc1 XPL
    v_mov_b32 v249, 1
    s_mov_b64 exec, 0xff
    buffer_atomic_add v249, v7, s[20:23], s49 offen sc1
    s_mov_b64 exec, -1
XPL:
    s_waitcnt vmcnt(15)
    ds_read_b128 v[80:83], v4 offset:4096
    ds_read_b128 v[84:87], v5 offset:4096
    ds_read_b128 v[88:91], v12 offset:4096
    ds_read_b128 v[92:95], v13 offset:4096
    s_waitcnt vmcnt(11)
    ds_read_b128 v[96:99], v8 offset:0
    ds_read_b128 v[100:103], v9 offset:0
    ds_read_b128 v[104:107], v10 offset:0
    ds_read_b128 v[108:111], v11 offset:0
    s_waitcnt vmcnt(0)
    ds_read_b128 v[112:115], v4 offset:0
    ds_read_b128 v[116:119], v5 offset:0
    ds_read_b128 v[120:123], v12 offset:0
    ds_read_b128 v[124:127], v13 offset:0
    s_waitcnt vmcnt(0) lgkmcnt(0)
A_P2:
    s_cmp_lg_u32 s24, 0
    s_cbranch_scc1 ND7
    s_mov_b32 s62, 40000
NT7:
    v_readfirstlane_b32 s60, v248
    s_nop 1
    s_cmp_ge_u32 s60, 8
    s_cbranch_scc1 ND7
    s_sub_u32 s62, s62, 1
    s_cbranch_scc1 ND7
    s_sleep 8
    global_load_dword v248, v255, s[92:93] sc1
    s_waitcnt vmcnt(0)
    s_branch NT7
ND7:
    s_barrier
    ds_read_b64_tr_b16 v[176:177], v15 offset:0
    ds_read_b64_tr_b16 v[178:179], v15 offset:256
    ds_read_b64_tr_b16 v[180:181], v15 offset:12288
    ds_read_b64_tr_b16 v[182:183], v15 offset:12544
    ds_read_b64_tr_b16 v[184:185], v15 offset:24576
    ds_read_b64_tr_b16 v[186:187], v15 offset:24832
    ds_read_b64_tr_b16 v[188:189], v15 offset:36864
    ds_read_b64_tr_b16 v[190:191], v15 offset:37120
    ds_read_b64_tr_b16 v[192:193], v15 offset:1024
    ds_read_b64_tr_b16 v[194:195], v15 offset:1280
    ds_read_b64_tr_b16 v[196:197], v15 offset:13312
    ds_read_b64_tr_b16 v[198:199], v15 offset:13568
    ds_read_b64_tr_b16 v[200:201], v15 offset:25600
    ds_read_b64_tr_b16 v[202:203], v15 offset:25856
    s_waitcnt lgkmcnt(12)
    v_mfma_f32_32x32x16_bf16 v[128:143], v[176:179], v[16:19], 0
    s_cmp_eq_u32 s54, 7
    s_cselect_b32 s59, 1, s24
    s_mul_i32 s33, s26, 28
    ds_read_b64_tr_b16 v[204:205], v15 offset:37888
    ds_read_b64_tr_b16 v[206:207], v15 offset:38144
    s_waitcnt lgkmcnt(12)
    v_mfma_f32_32x32x16_bf16 v[128:143], v[180:183], v[20:23], v[128:143]
    s_lshr_b32 s44, s33, 6
    s_add_u32 s34, s33, 27
    s_lshr_b32 s34, s34, 6
    ds_read_b64_tr_b16 v[176:177], v15 offset:2048
    ds_read_b64_tr_b16 v[178:179], v15 offset:2304
    s_waitcnt lgkmcnt(12)
    v_mfma_f32_32x32x16_bf16 v[128:143], v[184:187], v[24:27], v[128:143]
    s_sub_u32 s34, s34, s44
    s_lshl_b32 s34, s34, 1
    s_add_u32 s58, s34, 2
    ds_read_b64_tr_b16 v[180:181], v15 offset:14336
    ds_read_b64_tr_b16 v[182:183], v15 offset:14592
    s_waitcnt lgkmcnt(12)
    v_mfma_f32_32x32x16_bf16 v[128:143], v[188:191], v[28:31], v[128:143]
    v_lshrrev_b32 v4, 5, v1
    v_lshlrev_b32 v249, 9, v1
    v_mov_b32 v250, 0
    ds_read_b64_tr_b16 v[184:185], v15 offset:26624
    ds_read_b64_tr_b16 v[186:187], v15 offset:26880
    s_waitcnt lgkmcnt(12)
    v_mfma_f32_32x32x16_bf16 v[128:143], v[192:195], v[32:35], v[128:143]
    s_lshl_b32 s34, s26, 11
    s_lshl_b32 s36, s24, 7
    s_add_u32 s34, s34, s36
    ds_read_b64_tr_b16 v[188:189], v15 offset:38912
    ds_read_b64_tr_b16 v[190:191], v15 offset:39168
    s_waitcnt lgkmcnt(12)
    v_mfma_f32_32x32x16_bf16 v[128:143], v[196:199], v[36:39], v[128:143]
    s_add_u32 s53, s34, 6750208
    s_mov_b32 s46, 0x3e8b97f6
    s_mov_b32 s47, s46
    ds_read_b64_tr_b16 v[192:193], v15 offset:3072
    ds_read_b64_tr_b16 v[194:195], v15 offset:3328
    s_waitcnt lgkmcnt(12)
    v_mfma_f32_32x32x16_bf16 v[128:143], v[200:203], v[40:43], v[128:143]
    s_lshl_b32 s36, s24, 11
    s_add_u32 s36, s36, 49152
    v_add_u32 v6, s36, v2
    ds_read_b64_tr_b16 v[196:197], v15 offset:15360
    ds_read_b64_tr_b16 v[198:199], v15 offset:15616
    s_waitcnt lgkmcnt(12)
    v_mfma_f32_32x32x16_bf16 v[128:143], v[204:207], v[44:47], v[128:143]
    v_xor_b32 v7, 2048, v6
    v_xor_b32 v8, 4096, v6
    v_xor_b32 v9, 6144, v6
    ds_read_b64_tr_b16 v[200:201], v15 offset:27648
    ds_read_b64_tr_b16 v[202:203], v15 offset:27904
    s_waitcnt lgkmcnt(12)
    v_mfma_f32_32x32x16_bf16 v[128:143], v[176:179], v[48:51], v[128:143]
    s_lshr_b32 s34, s26, 1
    s_mul_i32 s34, s34, 3584
    s_and_b32 s36, s26, 1
    ds_read_b64_tr_b16 v[204:205], v15 offset:39936
    ds_read_b64_tr_b16 v[206:207], v15 offset:40192
    s_waitcnt lgkmcnt(12)
    v_mfma_f32_32x32x16_bf16 v[128:143], v[180:183], v[52:55], v[128:143]
    s_lshl_b32 s37, s36, 11
    s_add_u32 s34, s34, s37
    v_add_u32 v10, s34, v2
    ds_read_b64_tr_b16 v[176:177], v15 offset:4096
    ds_read_b64_tr_b16 v[178:179], v15 offset:4352
    s_waitcnt lgkmcnt(12)
    v_mfma_f32_32x32x16_bf16 v[128:143], v[184:187], v[56:59], v[128:143]
    v_add_u32 v11, 1024, v10
    s_mul_i32 s37, s36, 2040
    s_mov_b32 exec_lo, 0
    v_subrev_u32 v11, s37, v11
    s_mov_b32 exec_lo, -1
    ds_read_b64_tr_b16 v[180:181], v15 offset:16384
    ds_read_b64_tr_b16 v[182:183], v15 offset:16640
    s_waitcnt lgkmcnt(12)
    v_mfma_f32_32x32x16_bf16 v[128:143], v[188:191], v[60:63], v[128:143]
    v_and_b32 v5, 31, v1
    v_add_u32 v3, s33, v5
    v_lshrrev_b32 v5, 6, v3
    ds_read_b64_tr_b16 v[184:185], v15 offset:28672
    ds_read_b64_tr_b16 v[186:187], v15 offset:28928
    s_waitcnt lgkmcnt(12)
    v_mfma_f32_32x32x16_bf16 v[128:143], v[192:195], v[64:67], v[128:143]
    v_lshlrev_b32 v5, 7, v5
    v_lshl_add_u32 v12, v3, 4, v5
    s_mul_i32 s34, s44, 1152
    ds_read_b64_tr_b16 v[188:189], v15 offset:40960
    ds_read_b64_tr_b16 v[190:191], v15 offset:41216
    s_waitcnt lgkmcnt(12)
    v_mfma_f32_32x32x16_bf16 v[128:143], v[196:199], v[68:71], v[128:143]
    s_add_u32 s34, s34, 1024
    s_add_u32 s37, s34, 16
    s_mov_b32 exec_lo, 0xf0000000
    s_mov_b32 exec_hi, 0xf0000000
    v_mov_b32 v12, s37
    s_mov_b64 exec, -1
    ds_read_b64_tr_b16 v[192:193], v15 offset:5120
    ds_read_b64_tr_b16 v[194:195], v15 offset:5376
    s_waitcnt lgkmcnt(12)
    v_mfma_f32_32x32x16_bf16 v[128:143], v[200:203], v[72:75], v[128:143]
    v_writelane_b32 v12, s34, 28
    v_writelane_b32 v12, s34, 60
    s_movk_i32 s34, 8064
    ds_read_b64_tr_b16 v[196:197], v15 offset:17408
    ds_read_b64_tr_b16 v[198:199], v15 offset:17664
    s_waitcnt lgkmcnt(12)
    v_mfma_f32_32x32x16_bf16 v[128:143], v[204:207], v[76:79], v[128:143]
    v_mad_u32_u24 v12, v4, s34, v12
    v_add_u32 v13, 16128, v12
    s_mul_i32 s34, s24, 114688
    ds_read_b64_tr_b16 v[200:201], v15 offset:29696
    ds_read_b64_tr_b16 v[202:203], v15 offset:29952
    s_waitcnt lgkmcnt(12)
    v_mfma_f32_32x32x16_bf16 v[128:143], v[176:179], v[80:83], v[128:143]
    s_mul_i32 s37, s24, 129024
    s_add_u32 s37, s37, 2097152
    s_add_u32 s12, s94, s34
    s_addc_u32 s13, s95, 0
    ds_read_b64_tr_b16 v[204:205], v15 offset:41984
    ds_read_b64_tr_b16 v[206:207], v15 offset:42240
    s_waitcnt lgkmcnt(12)
    v_mfma_f32_32x32x16_bf16 v[128:143], v[180:183], v[84:87], v[128:143]
    s_mov_b32 s14, 1490944
    s_mov_b32 s15, 0x00020000
    s_add_u32 s16, s94, s37
    s_addc_u32 s17, s95, 0
    ds_read_b64_tr_b16 v[176:177], v15 offset:6144
    ds_read_b64_tr_b16 v[178:179], v15 offset:6400
    s_waitcnt lgkmcnt(12)
    v_mfma_f32_32x32x16_bf16 v[128:143], v[184:187], v[88:91], v[128:143]
    s_mov_b32 s18, 1677312
    s_mov_b32 s19, 0x00020000
    s_mov_b32 s63, 15
    ds_read_b64_tr_b16 v[180:181], v15 offset:18432
    ds_read_b64_tr_b16 v[182:183], v15 offset:18688
    s_waitcnt lgkmcnt(12)
    v_mfma_f32_32x32x16_bf16 v[128:143], v[188:191], v[92:95], v[128:143]
    v_mov_b32 v252, 0x3f803f80
    v_mov_b32 v253, 0x3f80
    v_mov_b32 v216, 0
    ds_read_b64_tr_b16 v[184:185], v15 offset:30720
    ds_read_b64_tr_b16 v[186:187], v15 offset:30976
    s_waitcnt lgkmcnt(12)
    v_mfma_f32_32x32x16_bf16 v[128:143], v[192:195], v[96:99], v[128:143]
    v_mov_b32 v217, 0
    v_mov_b32 v218, 0
    v_mov_b32 v219, 0
    ds_read_b64_tr_b16 v[188:189], v15 offset:43008
    ds_read_b64_tr_b16 v[190:191], v15 offset:43264
    s_waitcnt lgkmcnt(12)
    v_mfma_f32_32x32x16_bf16 v[128:143], v[196:199], v[100:103], v[128:143]
    v_mov_b32 v220, 0
    v_mov_b32 v221, 0
    v_mov_b32 v222, 0
    s_waitcnt lgkmcnt(10)
    v_mfma_f32_32x32x16_bf16 v[128:143], v[200:203], v[104:107], v[128:143]
    v_mov_b32 v223, 0
    v_mov_b32 v224, 0
    v_mov_b32 v225, 0
    v_mov_b32 v226, 0
    v_mov_b32 v227, 0
    s_waitcnt lgkmcnt(8)
    v_mfma_f32_32x32x16_bf16 v[128:143], v[204:207], v[108:111], v[128:143]
    s_mov_b32 s41, 0
    s_waitcnt lgkmcnt(6)
    v_mfma_f32_32x32x16_bf16 v[128:143], v[176:179], v[112:115], v[128:143]
    s_waitcnt lgkmcnt(4)
    v_mfma_f32_32x32x16_bf16 v[128:143], v[180:183], v[116:119], v[128:143]
    s_waitcnt lgkmcnt(2)
    v_mfma_f32_32x32x16_bf16 v[128:143], v[184:187], v[120:123], v[128:143]
    s_waitcnt lgkmcnt(0)
    v_mfma_f32_32x32x16_bf16 v[128:143], v[188:191], v[124:127], v[128:143]
    v_mfma_f32_32x32x16_bf16 v[48:63], v[216:219], v[216:219], 0
    v_mfma_f32_32x32x16_bf16 v[64:79], v[216:219], v[216:219], 0
    v_mfma_f32_32x32x16_bf16 v[80:95], v[216:219], v[216:219], 0
    v_mfma_f32_32x32x16_bf16 v[96:111], v[216:219], v[216:219], 0
    s_cmp_lg_u32 s59, 0
    s_waitcnt vmcnt(0)
    s_barrier
    s_cbranch_scc1 A_NOPUB
    v_mov_b32 v248, 1
    s_mov_b64 exec, s[56:57]
    buffer_atomic_add v248, v243, s[20:23], s42 offen sc1
    s_mov_b64 exec, -1
A_NOPUB:
    s_setprio 2
    s_mov_b64 exec, 15
    buffer_atomic_umax v250, v249, s[20:23], s53 offen sc0 sc1
    s_mov_b64 exec, -1
    s_nop 0
    v_mul_f32 v128, s46, v128
    v_mul_f32 v129, s46, v129
    v_mul_f32 v130, s46, v130
    v_mul_f32 v131, s46, v131
    v_mul_f32 v132, s46, v132
    v_mul_f32 v133, s46, v133
    v_mul_f32 v134, s46, v134
    v_mul_f32 v135, s46, v135
    v_mul_f32 v136, s46, v136
    v_mul_f32 v137, s46, v137
    v_mul_f32 v138, s46, v138
    v_mul_f32 v139, s46, v139
    v_mul_f32 v140, s46, v140
    v_mul_f32 v141, s46, v141
    v_mul_f32 v142, s46, v142
    v_mul_f32 v143, s46, v143
    v_cvt_pk_bf16_f32 v16, v128, v129
    v_cvt_pk_bf16_f32 v17, v130, v131
    v_cvt_pk_bf16_f32 v18, v132, v133
    v_cvt_pk_bf16_f32 v19, v134, v135
    v_cvt_pk_bf16_f32 v20, v136, v137
    v_cvt_pk_bf16_f32 v21, v138, v139
    v_cvt_pk_bf16_f32 v22, v140, v141
    v_cvt_pk_bf16_f32 v23, v142, v143
    s_mov_b32 exec_lo, 0
    v_mov_b32 v22, 0
    v_mov_b32 v23, 0
    s_mov_b32 exec_lo, -1
    ds_write_b128 v6, v[16:19] offset:0
    ds_write_b128 v6, v[20:23] offset:1024
    s_waitcnt lgkmcnt(0)
    s_barrier
    ds_read_b128 v[24:27], v7 offset:0
    ds_read_b128 v[28:31], v7 offset:1024
    ds_read_b128 v[32:35], v8 offset:0
    ds_read_b128 v[36:39], v8 offset:1024
    ds_read_b128 v[40:43], v9 offset:0
    ds_read_b128 v[44:47], v9 offset:1024
    s_mov_b32 s42, 0x07060302
    s_min_u32 s33, s32, 27
    s_and_b32 s34, s33, 3
    s_lshl_b32 s47, s31, 2
    s_add_u32 s47, s47, s34
    s_lshr_b32 s48, s33, 2
    s_lshr_b32 s49, s24, 1
    s_lshl_b32 s33, s47, 1
    s_add_u32 s49, s49, s33
    s_and_b32 s50, s24, 1
    s_lshl_b32 s33, s48, 1
    s_add_u32 s50, s50, s33
    v_bfe_u32 v5, v1, 2, 2
    v_lshlrev_b32 v9, 7, v5
    v_bfe_u32 v5, v1, 4, 1
    v_lshl_add_u32 v9, v5, 6, v9
    v_and_b32 v5, 3, v1
    v_lshl_add_u32 v9, v5, 4, v9
    v_lshl_add_u32 v9, v4, 9, v9
    s_xor_b32 s33, s24, 1
    s_mul_i32 s33, s33, 12288
    s_add_u32 s33, s33, 0
    v_add_u32 v4, s33, v2
    s_xor_b32 s33, s24, 2
    s_mul_i32 s33, s33, 12288
    s_add_u32 s33, s33, 4096
    v_add_u32 v5, s33, v2
    s_xor_b32 s33, s24, 3
    s_mul_i32 s33, s33, 12288
    s_add_u32 s33, s33, 8192
    v_add_u32 v6, s33, v2
    s_mul_i32 s33, s24, 12288
    v_add_u32 v7, s33, v2
    v_or_b32 v8, 512, v7
    s_lshl_b32 s33, s35, 4
    s_add_u32 s33, s33, s26
    s_lshl_b32 s43, s33, 11
    s_add_u32 s43, s43, 8912896
    s_lshr_b32 s51, s35, 1
    s_lshl_b32 s51, s51, 9
    s_lshr_b32 s33, s26, 2
    s_lshl_b32 s33, s33, 7
    s_add_u32 s51, s51, s33
    s_add_u32 s51, s51, 6782976
    s_lshl_b32 s33, s50, 7
    s_add_u32 s33, s33, 6811648
    v_mov_b32 v14, s33
    v_mov_b32 v15, 64
    s_lshl_b32 s33, s49, 7
    s_add_u32 s33, s33, 6803456
    v_writelane_b32 v14, s33, 1
    v_writelane_b32 v15, 2, 1
    s_lshl_b32 s33, s24, 7
    s_add_u32 s33, s33, 6813696
    v_writelane_b32 v14, s33, 2
    v_writelane_b32 v15, 16, 2
    s_waitcnt vmcnt(0)
    s_mov_b32 s62, 40000
KPA:
    v_cmp_eq_u32 vcc, s58, v250
    s_nop 1
    s_and_b32 s5, vcc_lo, s63
    s_cbranch_scc1 KDA
    s_mov_b32 s5, s63
    s_sub_u32 s62, s62, 1
    s_cbranch_scc1 KDA
    s_sleep 1
    s_mov_b64 exec, 15
    buffer_atomic_umax v250, v249, s[20:23], s53 offen sc0 sc1
    s_mov_b64 exec, -1
    s_waitcnt vmcnt(0)
    s_branch KPA
KDA:
    s_ff1_i32_b32 s59, s5
    s_bitset0_b32 s63, s59
    s_bitset0_b32 s5, s59
    s_mul_i32 s44, s59, 458752
    s_mul_i32 s45, s59, 516096
    buffer_load_dwordx4 v[160:163], v10, s[12:15], s44 offen sc1
    buffer_load_dwordx4 v[164:167], v11, s[12:15], s44 offen sc1
    s_addk_i32 s44, 28672
    buffer_load_dwordx4 v[192:195], v12, s[16:19], s45 offen sc1
    buffer_load_dwordx4 v[196:199], v13, s[16:19], s45 offen sc1
    s_addk_i32 s45, 32256
    buffer_load_dwordx4 v[168:171], v10, s[12:15], s44 offen sc1
    buffer_load_dwordx4 v[172:175], v11, s[12:15], s44 offen sc1
    s_addk_i32 s44, 28672
    buffer_load_dwordx4 v[200:203], v12, s[16:19], s45 offen sc1
    buffer_load_dwordx4 v[204:207], v13, s[16:19], s45 offen sc1
    s_addk_i32 s45, 32256
    buffer_load_dwordx4 v[176:179], v10, s[12:15], s44 offen sc1
    buffer_load_dwordx4 v[180:183], v11, s[12:15], s44 offen sc1
    s_addk_i32 s44, 28672
    buffer_load_dwordx4 v[208:211], v12, s[16:19], s45 offen sc1
    buffer_load_dwordx4 v[212:215], v13, s[16:19], s45 offen sc1
    s_addk_i32 s45, 32256
    buffer_load_dwordx4 v[184:187], v10, s[12:15], s44 offen sc1
    buffer_load_dwordx4 v[188:191], v11, s[12:15], s44 offen sc1
    s_mov_b64 exec, 15
    buffer_atomic_umax v250, v249, s[20:23], s53 offen sc0 sc1
    s_mov_b64 exec, -1
    s_waitcnt lgkmcnt(0)
    s_waitcnt vmcnt(13)
    v_mov_b32_dpp v166, v252 quad_perm:[0,1,2,3] row_mask:0xc bank_mask:0xf
    v_mov_b32_dpp v167, v253 quad_perm:[0,1,2,3] row_mask:0xc bank_mask:0xf
    s_nop 0
    v_mfma_f32_32x32x16_bf16 v[128:143], v[160:163], v[16:19], 0
    v_mfma_f32_32x32x16_bf16 v[128:143], v[164:167], v[20:23], v[128:143]
    v_mfma_f32_32x32x16_bf16 v[232:247], v[160:163], v[24:27], 0
    v_mfma_f32_32x32x16_bf16 v[232:247], v[164:167], v[28:31], v[232:247]
    v_mfma_f32_32x32x16_bf16 v[144:159], v[160:163], v[32:35], 0
    v_mfma_f32_32x32x16_bf16 v[144:159], v[164:167], v[36:39], v[144:159]
    v_mfma_f32_32x32x16_bf16 v[112:127], v[160:163], v[40:43], 0
    v_mfma_f32_32x32x16_bf16 v[112:127], v[164:167], v[44:47], v[112:127]
    s_nop 5
    v_max3_f32 v228, v128, v129, v130
    v_max3_f32 v228, v228, v131, v132
    v_max3_f32 v228, v228, v133, v134
    v_max3_f32 v228, v228, v135, v136
    v_max3_f32 v229, v232, v233, v234
    v_max3_f32 v229, v229, v235, v236
    v_max3_f32 v229, v229, v237, v238
    v_max3_f32 v229, v229, v239, v240
    v_max3_f32 v230, v144, v145, v146
    v_max3_f32 v230, v230, v147, v148
    v_max3_f32 v230, v230, v149, v150
    v_max3_f32 v230, v230, v151, v152
    v_max3_f32 v231, v112, v113, v114
    v_max3_f32 v231, v231, v115, v116
    v_max3_f32 v231, v231, v117, v118
    v_max3_f32 v231, v231, v119, v120
A_SETMAX:
    s_mov_b32 exec_lo, 0
    v_sub_f32 v224, v224, v228
    v_sub_f32 v225, v225, v229
    v_and_b32 v232, 0xffff0000, v224
    v_and_b32 v233, 0xffff0000, v225
    v_sub_f32 v232, v224, v232
    v_sub_f32 v233, v225, v233
    v_and_b32 v236, 0xffff0000, v232
    v_and_b32 v237, 0xffff0000, v233
    v_sub_f32 v236, v232, v236
    v_sub_f32 v237, v233, v237
    v_perm_b32 v22, v232, v224, s42
    v_lshrrev_b32 v23, 16, v236
    v_perm_b32 v30, v233, v225, s42
    v_lshrrev_b32 v31, 16, v237
    s_mov_b32 exec_lo, -1
    v_mfma_f32_32x32x16_bf16 v[112:127], v[160:163], v[16:19], 0
    v_mfma_f32_32x32x16_bf16 v[112:127], v[164:167], v[20:23], v[112:127]
    s_mov_b32 exec_lo, 0
    v_sub_f32 v226, v226, v230
    v_sub_f32 v227, v227, v231
    v_and_b32 v234, 0xffff0000, v226
    v_and_b32 v235, 0xffff0000, v227
    v_sub_f32 v234, v226, v234
    v_sub_f32 v235, v227, v235
    v_and_b32 v238, 0xffff0000, v234
    v_and_b32 v239, 0xffff0000, v235
    v_sub_f32 v238, v234, v238
    v_sub_f32 v239, v235, v239
    v_perm_b32 v38, v234, v226, s42
    v_lshrrev_b32 v39, 16, v238
    v_perm_b32 v46, v235, v227, s42
    v_lshrrev_b32 v47, 16, v239
    s_mov_b32 exec_lo, -1
    v_mov_b32 v152, 0
    v_mov_b32 v153, 0
    v_mov_b32 v154, 0
    v_mov_b32 v155, 0
    v_mov_b32 v156, 0
    v_mov_b32 v157, 0
    v_mov_b32 v158, 0
    v_mov_b32 v159, 0
    s_mov_b32 s46, 4
    s_movk_i32 s60, 28672
    s_movk_i32 s61, 32256
    s_setprio 1
A_LOOP:
    v_mfma_f32_32x32x16_bf16 v[128:143], v[160:163], v[24:27], 0
    v_exp_f32 v112, v112
    v_exp_f32 v113, v113
    v_exp_f32 v114, v114
    v_exp_f32 v115, v115
    v_cvt_pk_bf16_f32 v144, v112, v113
    v_cvt_pk_bf16_f32 v145, v114, v115
    v_mfma_f32_32x32x16_bf16 v[128:143], v[164:167], v[28:31], v[128:143]
    v_exp_f32 v116, v116
    v_exp_f32 v117, v117
    v_exp_f32 v118, v118
    v_exp_f32 v119, v119
    v_cvt_pk_bf16_f32 v146, v116, v117
    v_cvt_pk_bf16_f32 v147, v118, v119
    v_mfma_f32_32x32x16_bf16 v[96:111], v[216:219], v[152:155], v[96:111]
    buffer_load_dwordx4 v[216:219], v12, s[16:19], s45 offen sc1
    v_exp_f32 v120, v120
    v_exp_f32 v121, v121
    v_exp_f32 v122, v122
    v_exp_f32 v123, v123
    v_cvt_pk_bf16_f32 v148, v120, v121
    v_cvt_pk_bf16_f32 v149, v122, v123
    v_mfma_f32_32x32x16_bf16 v[96:111], v[220:223], v[156:159], v[96:111]
    buffer_load_dwordx4 v[220:223], v13, s[16:19], s45 offen sc1
    v_exp_f32 v124, v124
    v_exp_f32 v125, v125
    v_exp_f32 v126, v126
    v_exp_f32 v127, v127
    v_cvt_pk_bf16_f32 v150, v124, v125
    v_cvt_pk_bf16_f32 v151, v126, v127
    v_mfma_f32_32x32x16_bf16 v[112:127], v[160:163], v[32:35], 0
    s_cmp_le_u32 s5, 128
    v_exp_f32 v128, v128
    v_exp_f32 v129, v129
    v_exp_f32 v130, v130
    v_exp_f32 v131, v131
    v_cvt_pk_bf16_f32 v152, v128, v129
    v_cvt_pk_bf16_f32 v153, v130, v131
    v_mfma_f32_32x32x16_bf16 v[112:127], v[164:167], v[36:39], v[112:127]
    s_waitcnt vmcnt(12)
    v_exp_f32 v132, v132
    v_exp_f32 v133, v133
    v_exp_f32 v134, v134
    v_exp_f32 v135, v135
    v_cvt_pk_bf16_f32 v154, v132, v133
    v_cvt_pk_bf16_f32 v155, v134, v135
    v_mfma_f32_32x32x16_bf16 v[48:63], v[192:195], v[144:147], v[48:63]
    s_cbranch_scc1 A_SLOW
A_SLOWR:
    v_exp_f32 v136, v136
    v_exp_f32 v137, v137
    v_exp_f32 v138, v138
    v_exp_f32 v139, v139
    v_cvt_pk_bf16_f32 v156, v136, v137
    v_cvt_pk_bf16_f32 v157, v138, v139
    v_mfma_f32_32x32x16_bf16 v[48:63], v[196:199], v[148:151], v[48:63]
    s_ff1_i32_b32 s59, s5
    v_exp_f32 v140, v140
    v_exp_f32 v141, v141
    v_exp_f32 v142, v142
    v_exp_f32 v143, v143
    v_cvt_pk_bf16_f32 v158, v140, v141
    v_cvt_pk_bf16_f32 v159, v142, v143
    v_mfma_f32_32x32x16_bf16 v[128:143], v[160:163], v[40:43], 0
    s_mul_i32 s44, s59, 458752
    v_exp_f32 v112, v112
    v_exp_f32 v113, v113
    v_exp_f32 v114, v114
    v_exp_f32 v115, v115
    v_cvt_pk_bf16_f32 v144, v112, v113
    v_cvt_pk_bf16_f32 v145, v114, v115
    v_mfma_f32_32x32x16_bf16 v[128:143], v[164:167], v[44:47], v[128:143]
    buffer_load_dwordx4 v[160:163], v10, s[12:15], s44 offen sc1
    v_exp_f32 v116, v116
    v_exp_f32 v117, v117
    v_exp_f32 v118, v118
    v_exp_f32 v119, v119
    v_cvt_pk_bf16_f32 v146, v116, v117
    v_cvt_pk_bf16_f32 v147, v118, v119
    v_mfma_f32_32x32x16_bf16 v[64:79], v[192:195], v[152:155], v[64:79]
    buffer_load_dwordx4 v[164:167], v11, s[12:15], s44 offen sc1
    v_exp_f32 v120, v120
    v_exp_f32 v121, v121
    v_exp_f32 v122, v122
    v_exp_f32 v123, v123
    v_cvt_pk_bf16_f32 v148, v120, v121
    v_cvt_pk_bf16_f32 v149, v122, v123
    v_mfma_f32_32x32x16_bf16 v[64:79], v[196:199], v[156:159], v[64:79]
    s_waitcnt vmcnt(12)
    v_exp_f32 v124, v124
    v_exp_f32 v125, v125
    v_exp_f32 v126, v126
    v_exp_f32 v127, v127
    v_cvt_pk_bf16_f32 v150, v124, v125
    v_cvt_pk_bf16_f32 v151, v126, v127
    v_mfma_f32_32x32x16_bf16 v[112:127], v[168:171], v[16:19], 0
    s_mul_i32 s45, s59, 516096
    v_mov_b32_dpp v174, v252 quad_perm:[0,1,2,3] row_mask:0xc bank_mask:0xf
    v_mov_b32_dpp v175, v253 quad_perm:[0,1,2,3] row_mask:0xc bank_mask:0xf
    v_exp_f32 v128, v128
    v_exp_f32 v129, v129
    v_exp_f32 v130, v130
    v_exp_f32 v131, v131
    v_cvt_pk_bf16_f32 v152, v128, v129
    v_cvt_pk_bf16_f32 v153, v130, v131
    v_mfma_f32_32x32x16_bf16 v[112:127], v[172:175], v[20:23], v[112:127]
    s_add_u32 s44, s44, s60
    v_exp_f32 v132, v132
    v_exp_f32 v133, v133
    v_exp_f32 v134, v134
    v_exp_f32 v135, v135
    v_cvt_pk_bf16_f32 v154, v132, v133
    v_cvt_pk_bf16_f32 v155, v134, v135
    v_mfma_f32_32x32x16_bf16 v[80:95], v[192:195], v[144:147], v[80:95]
    s_bitset0_b32 s63, s59
    v_exp_f32 v136, v136
    v_exp_f32 v137, v137
    v_exp_f32 v138, v138
    v_exp_f32 v139, v139
    v_cvt_pk_bf16_f32 v156, v136, v137
    v_cvt_pk_bf16_f32 v157, v138, v139
    v_mfma_f32_32x32x16_bf16 v[80:95], v[196:199], v[148:151], v[80:95]
    s_bitset0_b32 s5, s59
    v_exp_f32 v140, v140
    v_exp_f32 v141, v141
    v_exp_f32 v142, v142
    v_exp_f32 v143, v143
    v_cvt_pk_bf16_f32 v158, v140, v141
    v_cvt_pk_bf16_f32 v159, v142, v143
    v_mfma_f32_32x32x16_bf16 v[128:143], v[168:171], v[24:27], 0
    s_cmp_le_u32 s46, 2
    v_exp_f32 v112, v112
    v_exp_f32 v113, v113
    v_exp_f32 v114, v114
    v_exp_f32 v115, v115
    v_cvt_pk_bf16_f32 v144, v112, v113
    v_cvt_pk_bf16_f32 v145, v114, v115
    v_mfma_f32_32x32x16_bf16 v[128:143], v[172:175], v[28:31], v[128:143]
    s_cbranch_scc1 A_LLOAD
A_LLOADR:
    v_exp_f32 v116, v116
    v_exp_f32 v117, v117
    v_exp_f32 v118, v118
    v_exp_f32 v119, v119
    v_cvt_pk_bf16_f32 v146, v116, v117
    v_cvt_pk_bf16_f32 v147, v118, v119
    v_mfma_f32_32x32x16_bf16 v[96:111], v[192:195], v[152:155], v[96:111]
    buffer_load_dwordx4 v[192:195], v12, s[16:19], s45 offen sc1
    v_exp_f32 v120, v120
    v_exp_f32 v121, v121
    v_exp_f32 v122, v122
    v_exp_f32 v123, v123
    v_cvt_pk_bf16_f32 v148, v120, v121
    v_cvt_pk_bf16_f32 v149, v122, v123
    v_mfma_f32_32x32x16_bf16 v[96:111], v[196:199], v[156:159], v[96:111]
    buffer_load_dwordx4 v[196:199], v13, s[16:19], s45 offen sc1
    v_exp_f32 v124, v124
    v_exp_f32 v125, v125
    v_exp_f32 v126, v126
    v_exp_f32 v127, v127
    v_cvt_pk_bf16_f32 v150, v124, v125
    v_cvt_pk_bf16_f32 v151, v126, v127
    v_mfma_f32_32x32x16_bf16 v[112:127], v[168:171], v[32:35], 0
    s_add_u32 s45, s45, s61
    v_exp_f32 v128, v128
    v_exp_f32 v129, v129
    v_exp_f32 v130, v130
    v_exp_f32 v131, v131
    v_cvt_pk_bf16_f32 v152, v128, v129
    v_cvt_pk_bf16_f32 v153, v130, v131
    v_mfma_f32_32x32x16_bf16 v[112:127], v[172:175], v[36:39], v[112:127]
    s_waitcnt vmcnt(12)
    v_exp_f32 v132, v132
    v_exp_f32 v133, v133
    v_exp_f32 v134, v134
    v_exp_f32 v135, v135
    v_cvt_pk_bf16_f32 v154, v132, v133
    v_cvt_pk_bf16_f32 v155, v134, v135
    v_mfma_f32_32x32x16_bf16 v[48:63], v[200:203], v[144:147], v[48:63]
    v_exp_f32 v136, v136
    v_exp_f32 v137, v137
    v_exp_f32 v138, v138
    v_exp_f32 v139, v139
    v_cvt_pk_bf16_f32 v156, v136, v137
    v_cvt_pk_bf16_f32 v157, v138, v139
    v_mfma_f32_32x32x16_bf16 v[48:63], v[204:207], v[148:151], v[48:63]
    v_exp_f32 v140, v140
    v_exp_f32 v141, v141
    v_exp_f32 v142, v142
    v_exp_f32 v143, v143
    v_cvt_pk_bf16_f32 v158, v140, v141
    v_cvt_pk_bf16_f32 v159, v142, v143
    v_mfma_f32_32x32x16_bf16 v[128:143], v[168:171], v[40:43], 0
    v_exp_f32 v112, v112
    v_exp_f32 v113, v113
    v_exp_f32 v114, v114
    v_exp_f32 v115, v115
    v_cvt_pk_bf16_f32 v144, v112, v113
    v_cvt_pk_bf16_f32 v145, v114, v115
    v_mfma_f32_32x32x16_bf16 v[128:143], v[172:175], v[44:47], v[128:143]
    buffer_load_dwordx4 v[168:171], v10, s[12:15], s44 offen sc1
    v_exp_f32 v116, v116
    v_exp_f32 v117, v117
    v_exp_f32 v118, v118
    v_exp_f32 v119, v119
    v_cvt_pk_bf16_f32 v146, v116, v117
    v_cvt_pk_bf16_f32 v147, v118, v119
    v_mfma_f32_32x32x16_bf16 v[64:79], v[200:203], v[152:155], v[64:79]
    buffer_load_dwordx4 v[172:175], v11, s[12:15], s44 offen sc1
    v_exp_f32 v120, v120
    v_exp_f32 v121, v121
    v_exp_f32 v122, v122
    v_exp_f32 v123, v123
    v_cvt_pk_bf16_f32 v148, v120, v121
    v_cvt_pk_bf16_f32 v149, v122, v123
    v_mfma_f32_32x32x16_bf16 v[64:79], v[204:207], v[156:159], v[64:79]
    s_waitcnt vmcnt(12)
    v_exp_f32 v124, v124
    v_exp_f32 v125, v125
    v_exp_f32 v126, v126
    v_exp_f32 v127, v127
    v_cvt_pk_bf16_f32 v150, v124, v125
    v_cvt_pk_bf16_f32 v151, v126, v127
    v_mfma_f32_32x32x16_bf16 v[112:127], v[176:179], v[16:19], 0
    v_mov_b32_dpp v182, v252 quad_perm:[0,1,2,3] row_mask:0xc bank_mask:0xf
    v_mov_b32_dpp v183, v253 quad_perm:[0,1,2,3] row_mask:0xc bank_mask:0xf
    v_exp_f32 v128, v128
    v_exp_f32 v129, v129
    v_exp_f32 v130, v130
    v_exp_f32 v131, v131
    v_cvt_pk_bf16_f32 v152, v128, v129
    v_cvt_pk_bf16_f32 v153, v130, v131
    v_mfma_f32_32x32x16_bf16 v[112:127], v[180:183], v[20:23], v[112:127]
    s_add_u32 s44, s44, s60
    v_exp_f32 v132, v132
    v_exp_f32 v133, v133
    v_exp_f32 v134, v134
    v_exp_f32 v135, v135
    v_cvt_pk_bf16_f32 v154, v132, v133
    v_cvt_pk_bf16_f32 v155, v134, v135
    v_mfma_f32_32x32x16_bf16 v[80:95], v[200:203], v[144:147], v[80:95]
    v_exp_f32 v136, v136
    v_exp_f32 v137, v137
    v_exp_f32 v138, v138
    v_exp_f32 v139, v139
    v_cvt_pk_bf16_f32 v156, v136, v137
    v_cvt_pk_bf16_f32 v157, v138, v139
    v_mfma_f32_32x32x16_bf16 v[80:95], v[204:207], v[148:151], v[80:95]
    v_exp_f32 v140, v140
    v_exp_f32 v141, v141
    v_exp_f32 v142, v142
    v_exp_f32 v143, v143
    v_cvt_pk_bf16_f32 v158, v140, v141
    v_cvt_pk_bf16_f32 v159, v142, v143
    v_mfma_f32_32x32x16_bf16 v[128:143], v[176:179], v[24:27], 0
    v_exp_f32 v112, v112
    v_exp_f32 v113, v113
    v_exp_f32 v114, v114
    v_exp_f32 v115, v115
    v_cvt_pk_bf16_f32 v144, v112, v113
    v_cvt_pk_bf16_f32 v145, v114, v115
    v_mfma_f32_32x32x16_bf16 v[128:143], v[180:183], v[28:31], v[128:143]
    v_exp_f32 v116, v116
    v_exp_f32 v117, v117
    v_exp_f32 v118, v118
    v_exp_f32 v119, v119
    v_cvt_pk_bf16_f32 v146, v116, v117
    v_cvt_pk_bf16_f32 v147, v118, v119
    v_mfma_f32_32x32x16_bf16 v[96:111], v[200:203], v[152:155], v[96:111]
    buffer_load_dwordx4 v[200:203], v12, s[16:19], s45 offen sc1
    v_exp_f32 v120, v120
    v_exp_f32 v121, v121
    v_exp_f32 v122, v122
    v_exp_f32 v123, v123
    v_cvt_pk_bf16_f32 v148, v120, v121
    v_cvt_pk_bf16_f32 v149, v122, v123
    v_mfma_f32_32x32x16_bf16 v[96:111], v[204:207], v[156:159], v[96:111]
    buffer_load_dwordx4 v[204:207], v13, s[16:19], s45 offen sc1
    v_exp_f32 v124, v124
    v_exp_f32 v125, v125
    v_exp_f32 v126, v126
    v_exp_f32 v127, v127
    v_cvt_pk_bf16_f32 v150, v124, v125
    v_cvt_pk_bf16_f32 v151, v126, v127
    v_mfma_f32_32x32x16_bf16 v[112:127], v[176:179], v[32:35], 0
    s_add_u32 s45, s45, s61
    v_exp_f32 v128, v128
    v_exp_f32 v129, v129
    v_exp_f32 v130, v130
    v_exp_f32 v131, v131
    v_cvt_pk_bf16_f32 v152, v128, v129
    v_cvt_pk_bf16_f32 v153, v130, v131
    v_mfma_f32_32x32x16_bf16 v[112:127], v[180:183], v[36:39], v[112:127]
    s_waitcnt vmcnt(12)
    v_exp_f32 v132, v132
    v_exp_f32 v133, v133
    v_exp_f32 v134, v134
    v_exp_f32 v135, v135
    v_cvt_pk_bf16_f32 v154, v132, v133
    v_cvt_pk_bf16_f32 v155, v134, v135
    v_mfma_f32_32x32x16_bf16 v[48:63], v[208:211], v[144:147], v[48:63]
    v_exp_f32 v136, v136
    v_exp_f32 v137, v137
    v_exp_f32 v138, v138
    v_exp_f32 v139, v139
    v_cvt_pk_bf16_f32 v156, v136, v137
    v_cvt_pk_bf16_f32 v157, v138, v139
    v_mfma_f32_32x32x16_bf16 v[48:63], v[212:215], v[148:151], v[48:63]
    v_exp_f32 v140, v140
    v_exp_f32 v141, v141
    v_exp_f32 v142, v142
    v_exp_f32 v143, v143
    v_cvt_pk_bf16_f32 v158, v140, v141
    v_cvt_pk_bf16_f32 v159, v142, v143
    v_mfma_f32_32x32x16_bf16 v[128:143], v[176:179], v[40:43], 0
    v_exp_f32 v112, v112
    v_exp_f32 v113, v113
    v_exp_f32 v114, v114
    v_exp_f32 v115, v115
    v_cvt_pk_bf16_f32 v144, v112, v113
    v_cvt_pk_bf16_f32 v145, v114, v115
    v_mfma_f32_32x32x16_bf16 v[128:143], v[180:183], v[44:47], v[128:143]
    buffer_load_dwordx4 v[176:179], v10, s[12:15], s44 offen sc1
    v_exp_f32 v116, v116
    v_exp_f32 v117, v117
    v_exp_f32 v118, v118
    v_exp_f32 v119, v119
    v_cvt_pk_bf16_f32 v146, v116, v117
    v_cvt_pk_bf16_f32 v147, v118, v119
    v_mfma_f32_32x32x16_bf16 v[64:79], v[208:211], v[152:155], v[64:79]
    buffer_load_dwordx4 v[180:183], v11, s[12:15], s44 offen sc1
    v_exp_f32 v120, v120
    v_exp_f32 v121, v121
    v_exp_f32 v122, v122
    v_exp_f32 v123, v123
    v_cvt_pk_bf16_f32 v148, v120, v121
    v_cvt_pk_bf16_f32 v149, v122, v123
    v_mfma_f32_32x32x16_bf16 v[64:79], v[212:215], v[156:159], v[64:79]
    s_waitcnt vmcnt(12)
    v_exp_f32 v124, v124
    v_exp_f32 v125, v125
    v_exp_f32 v126, v126
    v_exp_f32 v127, v127
    v_cvt_pk_bf16_f32 v150, v124, v125
    v_cvt_pk_bf16_f32 v151, v126, v127
    v_mfma_f32_32x32x16_bf16 v[112:127], v[184:187], v[16:19], 0
    v_mov_b32_dpp v190, v252 quad_perm:[0,1,2,3] row_mask:0xc bank_mask:0xf
    v_mov_b32_dpp v191, v253 quad_perm:[0,1,2,3] row_mask:0xc bank_mask:0xf
    v_exp_f32 v128, v128
    v_exp_f32 v129, v129
    v_exp_f32 v130, v130
    v_exp_f32 v131, v131
    v_cvt_pk_bf16_f32 v152, v128, v129
    v_cvt_pk_bf16_f32 v153, v130, v131
    v_mfma_f32_32x32x16_bf16 v[112:127], v[188:191], v[20:23], v[112:127]
    s_add_u32 s44, s44, s60
    v_exp_f32 v132, v132
    v_exp_f32 v133, v133
    v_exp_f32 v134, v134
    v_exp_f32 v135, v135
    v_cvt_pk_bf16_f32 v154, v132, v133
    v_cvt_pk_bf16_f32 v155, v134, v135
    v_mfma_f32_32x32x16_bf16 v[80:95], v[208:211], v[144:147], v[80:95]
    v_exp_f32 v136, v136
    v_exp_f32 v137, v137
    v_exp_f32 v138, v138
    v_exp_f32 v139, v139
    v_cvt_pk_bf16_f32 v156, v136, v137
    v_cvt_pk_bf16_f32 v157, v138, v139
    v_mfma_f32_32x32x16_bf16 v[80:95], v[212:215], v[148:151], v[80:95]
    v_exp_f32 v140, v140
    v_exp_f32 v141, v141
    v_exp_f32 v142, v142
    v_exp_f32 v143, v143
    v_cvt_pk_bf16_f32 v158, v140, v141
    v_cvt_pk_bf16_f32 v159, v142, v143
    v_mfma_f32_32x32x16_bf16 v[128:143], v[184:187], v[24:27], 0
    v_exp_f32 v112, v112
    v_exp_f32 v113, v113
    v_exp_f32 v114, v114
    v_exp_f32 v115, v115
    v_cvt_pk_bf16_f32 v144, v112, v113
    v_cvt_pk_bf16_f32 v145, v114, v115
    v_mfma_f32_32x32x16_bf16 v[128:143], v[188:191], v[28:31], v[128:143]
    v_exp_f32 v116, v116
    v_exp_f32 v117, v117
    v_exp_f32 v118, v118
    v_exp_f32 v119, v119
    v_cvt_pk_bf16_f32 v146, v116, v117
    v_cvt_pk_bf16_f32 v147, v118, v119
    v_mfma_f32_32x32x16_bf16 v[96:111], v[208:211], v[152:155], v[96:111]
    buffer_load_dwordx4 v[208:211], v12, s[16:19], s45 offen sc1
    v_exp_f32 v120, v120
    v_exp_f32 v121, v121
    v_exp_f32 v122, v122
    v_exp_f32 v123, v123
    v_cvt_pk_bf16_f32 v148, v120, v121
    v_cvt_pk_bf16_f32 v149, v122, v123
    v_mfma_f32_32x32x16_bf16 v[96:111], v[212:215], v[156:159], v[96:111]
    buffer_load_dwordx4 v[212:215], v13, s[16:19], s45 offen sc1
    v_exp_f32 v124, v124
    v_exp_f32 v125, v125
    v_exp_f32 v126, v126
    v_exp_f32 v127, v127
    v_cvt_pk_bf16_f32 v150, v124, v125
    v_cvt_pk_bf16_f32 v151, v126, v127
    v_mfma_f32_32x32x16_bf16 v[112:127], v[184:187], v[32:35], 0
    s_add_u32 s45, s45, s61
    v_exp_f32 v128, v128
    v_exp_f32 v129, v129
    v_exp_f32 v130, v130
    v_exp_f32 v131, v131
    v_cvt_pk_bf16_f32 v152, v128, v129
    v_cvt_pk_bf16_f32 v153, v130, v131
    v_mfma_f32_32x32x16_bf16 v[112:127], v[188:191], v[36:39], v[112:127]
    s_waitcnt vmcnt(12)
    v_exp_f32 v132, v132
    v_exp_f32 v133, v133
    v_exp_f32 v134, v134
    v_exp_f32 v135, v135
    v_cvt_pk_bf16_f32 v154, v132, v133
    v_cvt_pk_bf16_f32 v155, v134, v135
    v_mfma_f32_32x32x16_bf16 v[48:63], v[216:219], v[144:147], v[48:63]
    v_exp_f32 v136, v136
    v_exp_f32 v137, v137
    v_exp_f32 v138, v138
    v_exp_f32 v139, v139
    v_cvt_pk_bf16_f32 v156, v136, v137
    v_cvt_pk_bf16_f32 v157, v138, v139
    v_mfma_f32_32x32x16_bf16 v[48:63], v[220:223], v[148:151], v[48:63]
    v_exp_f32 v140, v140
    v_exp_f32 v141, v141
    v_exp_f32 v142, v142
    v_exp_f32 v143, v143
    v_cvt_pk_bf16_f32 v158, v140, v141
    v_cvt_pk_bf16_f32 v159, v142, v143
    v_mfma_f32_32x32x16_bf16 v[128:143], v[184:187], v[40:43], 0
    v_exp_f32 v112, v112
    v_exp_f32 v113, v113
    v_exp_f32 v114, v114
    v_exp_f32 v115, v115
    v_cvt_pk_bf16_f32 v144, v112, v113
    v_cvt_pk_bf16_f32 v145, v114, v115
    v_mfma_f32_32x32x16_bf16 v[128:143], v[188:191], v[44:47], v[128:143]
    buffer_load_dwordx4 v[184:187], v10, s[12:15], s44 offen sc1
    v_exp_f32 v116, v116
    v_exp_f32 v117, v117
    v_exp_f32 v118, v118
    v_exp_f32 v119, v119
    v_cvt_pk_bf16_f32 v146, v116, v117
    v_cvt_pk_bf16_f32 v147, v118, v119
    v_mfma_f32_32x32x16_bf16 v[64:79], v[216:219], v[152:155], v[64:79]
    buffer_load_dwordx4 v[188:191], v11, s[12:15], s44 offen sc1
    v_exp_f32 v120, v120
    v_exp_f32 v121, v121
    v_exp_f32 v122, v122
    v_exp_f32 v123, v123
    v_cvt_pk_bf16_f32 v148, v120, v121
    v_cvt_pk_bf16_f32 v149, v122, v123
    v_mfma_f32_32x32x16_bf16 v[64:79], v[220:223], v[156:159], v[64:79]
    s_waitcnt vmcnt(12)
    v_exp_f32 v124, v124
    v_exp_f32 v125, v125
    v_exp_f32 v126, v126
    v_exp_f32 v127, v127
    v_cvt_pk_bf16_f32 v150, v124, v125
    v_cvt_pk_bf16_f32 v151, v126, v127
    v_mfma_f32_32x32x16_bf16 v[112:127], v[160:163], v[16:19], 0
    v_mov_b32_dpp v166, v252 quad_perm:[0,1,2,3] row_mask:0xc bank_mask:0xf
    v_mov_b32_dpp v167, v253 quad_perm:[0,1,2,3] row_mask:0xc bank_mask:0xf
    v_exp_f32 v128, v128
    v_exp_f32 v129, v129
    v_exp_f32 v130, v130
    v_exp_f32 v131, v131
    v_cvt_pk_bf16_f32 v152, v128, v129
    v_cvt_pk_bf16_f32 v153, v130, v131
    v_mfma_f32_32x32x16_bf16 v[112:127], v[164:167], v[20:23], v[112:127]
    v_exp_f32 v132, v132
    v_exp_f32 v133, v133
    v_exp_f32 v134, v134
    v_exp_f32 v135, v135
    v_cvt_pk_bf16_f32 v154, v132, v133
    v_cvt_pk_bf16_f32 v155, v134, v135
    v_mfma_f32_32x32x16_bf16 v[80:95], v[216:219], v[144:147], v[80:95]
    s_sub_u32 s46, s46, 1
    v_exp_f32 v136, v136
    v_exp_f32 v137, v137
    v_exp_f32 v138, v138
    v_exp_f32 v139, v139
    v_cvt_pk_bf16_f32 v156, v136, v137
    v_cvt_pk_bf16_f32 v157, v138, v139
    v_mfma_f32_32x32x16_bf16 v[80:95], v[220:223], v[148:151], v[80:95]
    s_cmp_lg_u32 s46, 0
    v_exp_f32 v140, v140
    v_exp_f32 v141, v141
    v_exp_f32 v142, v142
    v_exp_f32 v143, v143
    v_cvt_pk_bf16_f32 v158, v140, v141
    v_cvt_pk_bf16_f32 v159, v142, v143
    s_cbranch_scc1 A_LOOP
    s_nop 0
    v_mfma_f32_32x32x16_bf16 v[96:111], v[216:219], v[152:155], v[96:111]
    v_mfma_f32_32x32x16_bf16 v[96:111], v[220:223], v[156:159], v[96:111]
    v_mov_b32 v3, 0x5f800000
    s_mov_b32 exec_lo, 0
    v_cmp_nlt_f32 s[4:5], v60, v3
    v_cmp_nlt_f32 s[6:7], v76, v3
    v_cmp_nlt_f32 s[8:9], v92, v3
    v_mov_b32 v77, v225
    v_mov_b32 v93, v226
    s_mov_b32 exec_lo, -1
    ds_write_b128 v4, v[64:67] offset:0
    ds_write_b128 v4, v[68:71] offset:1024
    ds_write_b128 v4, v[72:75] offset:2048
    ds_write_b128 v4, v[76:79] offset:3072
    ds_write_b128 v5, v[80:83] offset:0
    ds_write_b128 v5, v[84:87] offset:1024
    ds_write_b128 v5, v[88:91] offset:2048
    ds_write_b128 v5, v[92:95] offset:3072
    s_mov_b32 exec_lo, 0
    v_cmp_nlt_f32 vcc, v108, v3
    v_mov_b32 v109, v227
    s_mov_b32 exec_lo, -1
    s_or_b32 s5, s5, s7
    s_or_b32 s5, s5, s9
    s_or_b32 s5, s5, vcc_hi
    s_andn2_b32 s5, s5, s41
    s_cbranch_scc1 A_FALLBACK
    ds_write_b128 v6, v[96:99] offset:0
    ds_write_b128 v6, v[100:103] offset:1024
    ds_write_b128 v6, v[104:107] offset:2048
    ds_write_b128 v6, v[108:111] offset:3072
    v_mov_b32 v232, v60
    v_mov_b32 v233, v60
    v_mov_b32 v240, v224
    v_add_u32 v10, 4096, v2
    s_lshl_b32 s33, s24, 13
    s_add_u32 s33, s33, 6291456
    s_lshl_b32 s36, s50, 15
    s_add_u32 s36, s36, s33
    s_xor_b32 s37, s50, 1
    s_lshl_b32 s37, s37, 15
    s_add_u32 s37, s37, s33
    v_lshrrev_b32 v11, 5, v1
    v_lshlrev_b32 v12, 6, v11
    s_lshl_b32 s38, s49, 7
    s_add_u32 s38, s38, 6094848
    v_and_b32 v13, 31, v1
    v_lshlrev_b32 v3, 12, v13
    v_lshl_add_u32 v3, v11, 4, v3
    s_lshl_b32 s39, s50, 17
    s_lshr_b32 s34, s49, 4
    s_lshl_b32 s34, s34, 10
    s_add_u32 s39, s39, s34
    s_and_b32 s34, s49, 15
    s_lshl_b32 s34, s34, 5
    s_add_u32 s39, s39, s34
    s_add_u32 s39, s39, 6881280
    s_cmp_lg_u32 s60, 1024
    s_cbranch_scc1 A_NOW0
    buffer_load_dwordx4 v[216:219], v2, s[20:23], s36 offen offset:0 sc1
    buffer_load_dwordx4 v[220:223], v2, s[20:23], s37 offen offset:0 sc1
A_NOW0:
    s_waitcnt lgkmcnt(0)
    s_barrier
    ds_read_b64 v[234:235], v8 offset:3072
    ds_read_b64 v[236:237], v8 offset:7168
    ds_read_b64 v[238:239], v8 offset:11264
    ds_read_b128 v[64:67], v7 offset:0
    ds_read_b128 v[68:71], v7 offset:1024
    ds_read_b128 v[72:75], v7 offset:2048
    ds_read_b128 v[76:79], v7 offset:3072
    ds_read_b128 v[80:83], v7 offset:4096
    ds_read_b128 v[84:87], v7 offset:5120
    ds_read_b128 v[88:91], v7 offset:6144
    ds_read_b128 v[92:95], v7 offset:7168
    ds_read_b128 v[96:99], v7 offset:8192
    ds_read_b128 v[100:103], v7 offset:9216
    ds_read_b128 v[104:107], v7 offset:10240
    ds_read_b128 v[108:111], v7 offset:11264
    v_permlane32_swap_b32 v232, v233
    v_permlane32_swap_b32 v240, v224
    s_waitcnt lgkmcnt(12)
    v_min3_f32 v228, v224, v235, v237
    v_min_f32 v228, v228, v239
    v_sub_f32 v112, v228, v224
    v_sub_f32 v114, v228, v235
    v_sub_f32 v116, v228, v237
    v_sub_f32 v118, v228, v239
    v_exp_f32 v112, v112
    v_exp_f32 v114, v114
    v_exp_f32 v116, v116
    v_exp_f32 v118, v118
    v_mul_f32 v229, v112, v233
    v_fmac_f32 v229, v114, v234
    v_fmac_f32 v229, v116, v236
    v_fmac_f32 v229, v118, v238
    v_rcp_f32 v229, v229
    s_nop 0
    v_mul_f32 v112, v112, v229
    v_mul_f32 v114, v114, v229
    v_mul_f32 v116, v116, v229
    v_mul_f32 v118, v118, v229
    v_pk_mul_f32 v[48:49], v[48:49], v[112:113] op_sel_hi:[1,0]
    v_pk_mul_f32 v[50:51], v[50:51], v[112:113] op_sel_hi:[1,0]
    v_pk_mul_f32 v[52:53], v[52:53], v[112:113] op_sel_hi:[1,0]
    v_pk_mul_f32 v[54:55], v[54:55], v[112:113] op_sel_hi:[1,0]
    v_pk_mul_f32 v[56:57], v[56:57], v[112:113] op_sel_hi:[1,0]
    v_pk_mul_f32 v[58:59], v[58:59], v[112:113] op_sel_hi:[1,0]
    v_pk_mul_f32 v[60:61], v[60:61], v[112:113] op_sel_hi:[1,0]
    v_pk_mul_f32 v[62:63], v[62:63], v[112:113] op_sel_hi:[1,0]
    s_waitcnt lgkmcnt(8)
    v_pk_fma_f32 v[48:49], v[64:65], v[114:115], v[48:49] op_sel_hi:[1,0,1]
    v_pk_fma_f32 v[50:51], v[66:67], v[114:115], v[50:51] op_sel_hi:[1,0,1]
    v_pk_fma_f32 v[52:53], v[68:69], v[114:115], v[52:53] op_sel_hi:[1,0,1]
    v_pk_fma_f32 v[54:55], v[70:71], v[114:115], v[54:55] op_sel_hi:[1,0,1]
    v_pk_fma_f32 v[56:57], v[72:73], v[114:115], v[56:57] op_sel_hi:[1,0,1]
    v_pk_fma_f32 v[58:59], v[74:75], v[114:115], v[58:59] op_sel_hi:[1,0,1]
    v_pk_fma_f32 v[60:61], v[76:77], v[114:115], v[60:61] op_sel_hi:[1,0,1]
    v_pk_fma_f32 v[62:63], v[78:79], v[114:115], v[62:63] op_sel_hi:[1,0,1]
    s_waitcnt lgkmcnt(4)
    v_pk_fma_f32 v[48:49], v[80:81], v[116:117], v[48:49] op_sel_hi:[1,0,1]
    v_pk_fma_f32 v[50:51], v[82:83], v[116:117], v[50:51] op_sel_hi:[1,0,1]
    v_pk_fma_f32 v[52:53], v[84:85], v[116:117], v[52:53] op_sel_hi:[1,0,1]
    v_pk_fma_f32 v[54:55], v[86:87], v[116:117], v[54:55] op_sel_hi:[1,0,1]
    v_pk_fma_f32 v[56:57], v[88:89], v[116:117], v[56:57] op_sel_hi:[1,0,1]
    v_pk_fma_f32 v[58:59], v[90:91], v[116:117], v[58:59] op_sel_hi:[1,0,1]
    v_pk_fma_f32 v[60:61], v[92:93], v[116:117], v[60:61] op_sel_hi:[1,0,1]
    v_pk_fma_f32 v[62:63], v[94:95], v[116:117], v[62:63] op_sel_hi:[1,0,1]
    s_waitcnt lgkmcnt(0)
    v_pk_fma_f32 v[48:49], v[96:97], v[118:119], v[48:49] op_sel_hi:[1,0,1]
    v_pk_fma_f32 v[50:51], v[98:99], v[118:119], v[50:51] op_sel_hi:[1,0,1]
    v_pk_fma_f32 v[52:53], v[100:101], v[118:119], v[52:53] op_sel_hi:[1,0,1]
    v_pk_fma_f32 v[54:55], v[102:103], v[118:119], v[54:55] op_sel_hi:[1,0,1]
    v_pk_fma_f32 v[56:57], v[104:105], v[118:119], v[56:57] op_sel_hi:[1,0,1]
    v_pk_fma_f32 v[58:59], v[106:107], v[118:119], v[58:59] op_sel_hi:[1,0,1]
    v_pk_fma_f32 v[60:61], v[108:109], v[118:119], v[60:61] op_sel_hi:[1,0,1]
    v_pk_fma_f32 v[62:63], v[110:111], v[118:119], v[62:63] op_sel_hi:[1,0,1]
    v_cvt_pk_bf16_f32 v144, v48, v49
    v_cvt_pk_bf16_f32 v145, v50, v51
    v_cvt_pk_bf16_f32 v146, v52, v53
    v_cvt_pk_bf16_f32 v147, v54, v55
    v_cvt_pk_bf16_f32 v148, v56, v57
    v_cvt_pk_bf16_f32 v149, v58, v59
    v_cvt_pk_bf16_f32 v150, v60, v61
    v_cvt_pk_bf16_f32 v151, v62, v63
    s_mov_b32 exec_lo, 0
    v_mov_b32 v150, 0
    v_mov_b32 v151, 0
    s_mov_b32 exec_lo, -1
    buffer_store_dwordx4 v[144:147], v9, s[20:23], s43 offen offset:0 sc1
    buffer_store_dwordx4 v[148:151], v9, s[20:23], s43 offen offset:1024 sc1
    s_barrier
    s_lshl_b32 s52, s47, 9
    s_lshl_b32 s33, s24, 7
    s_add_u32 s52, s52, s33
    s_add_u32 s52, s52, 6782976
    s_waitcnt vmcnt(0)
    v_mov_b32 v252, 1
    s_mov_b64 exec, 1
    buffer_atomic_add v252, v255, s[20:23], s51 offen sc1
    s_mov_b64 exec, -1
    s_cmp_ge_u32 s32, 28
    s_cbranch_scc1 L_END
    s_cmp_eq_u32 s60, 1024
    s_cbranch_scc1 A_WOK
    s_mov_b32 s62, 40000
FC8:
    v_cmp_ne_u32 vcc, v248, v15
    s_nop 1
    s_and_b32 s4, vcc_lo, 7
    s_cbranch_scc0 FD8
    s_sub_u32 s62, s62, 1
    s_cbranch_scc1 FD8
    s_sleep 16
    s_mov_b64 exec, 7
    buffer_load_dword v248, v14, s[20:23], 0 offen sc1
    s_mov_b64 exec, -1
    s_waitcnt vmcnt(0)
    s_branch FC8
FD8:
    buffer_load_dwordx4 v[216:219], v2, s[20:23], s36 offen offset:0 sc1
    buffer_load_dwordx4 v[220:223], v2, s[20:23], s37 offen offset:0 sc1
    buffer_load_dwordx4 v[160:163], v2, s[20:23], s36 offen offset:1024 sc1
    buffer_load_dwordx4 v[164:167], v2, s[20:23], s37 offen offset:1024 sc1
    buffer_load_dwordx4 v[168:171], v2, s[20:23], s36 offen offset:2048 sc1
    buffer_load_dwordx4 v[172:175], v2, s[20:23], s37 offen offset:2048 sc1
    buffer_load_dwordx4 v[176:179], v2, s[20:23], s36 offen offset:3072 sc1
    buffer_load_dwordx4 v[180:183], v2, s[20:23], s37 offen offset:3072 sc1
    buffer_load_dwordx4 v[184:187], v10, s[20:23], s36 offen offset:0 sc1
    buffer_load_dwordx4 v[188:191], v10, s[20:23], s37 offen offset:0 sc1
    buffer_load_dwordx4 v[192:195], v10, s[20:23], s36 offen offset:1024 sc1
    buffer_load_dwordx4 v[196:199], v10, s[20:23], s37 offen offset:1024 sc1
    buffer_load_dwordx4 v[200:203], v10, s[20:23], s36 offen offset:2048 sc1
    buffer_load_dwordx4 v[204:207], v10, s[20:23], s37 offen offset:2048 sc1
    buffer_load_dwordx4 v[208:211], v10, s[20:23], s36 offen offset:3072 sc1
    buffer_load_dwordx4 v[212:215], v10, s[20:23], s37 offen offset:3072 sc1
A_WOK:
    v_mov_b32 v250, 0
    s_mov_b64 exec, 1
    buffer_atomic_add v250, v255, s[20:23], s52 offen sc0 sc1
    s_mov_b64 exec, -1
    s_lshl_b32 s33, s24, 13
    s_add_u32 s33, s33, 8912896
    s_lshl_b32 s36, s49, 15
    s_add_u32 s36, s36, s33
    s_xor_b32 s37, s49, 1
    s_lshl_b32 s37, s37, 15
    s_add_u32 s37, s37, s33
    s_mov_b32 s12, s90
    s_mov_b32 s13, s91
    s_mov_b32 s14, 1835008
    s_mov_b32 s15, 0x00020000
    v_mul_u32_u24 v9, 14336, v11
    v_lshl_add_u32 v9, v13, 1, v9
    s_mul_i32 s44, s49, 28672
    s_lshl_b32 s33, s50, 6
    s_add_u32 s44, s44, s33
    s_add_u32 s45, s44, 3584
    s_add_u32 s46, s44, 7168
    s_add_u32 s47, s44, 10752
    s_waitcnt vmcnt(0)
    s_mov_b32 s62, 40000
FC9:
    v_readfirstlane_b32 s4, v250
    s_nop 1
    s_cmp_eq_u32 s4, 8
    s_cbranch_scc1 FD9
    s_sub_u32 s62, s62, 1
    s_cbranch_scc1 FD9
    s_sleep 1
    v_mov_b32 v250, 0
    s_mov_b64 exec, 1
    buffer_atomic_add v250, v255, s[20:23], s52 offen sc0 sc1
    s_mov_b64 exec, -1
    s_waitcnt vmcnt(0)
    s_branch FC9
FD9:
    buffer_load_dwordx4 v[52:55], v2, s[20:23], s37 offen offset:0 sc1
    buffer_load_dwordx4 v[60:63], v2, s[20:23], s37 offen offset:1024 sc1
    buffer_load_dwordx4 v[68:71], v2, s[20:23], s37 offen offset:2048 sc1
    buffer_load_dwordx4 v[76:79], v2, s[20:23], s37 offen offset:3072 sc1
    buffer_load_dwordx4 v[84:87], v10, s[20:23], s37 offen offset:0 sc1
    buffer_load_dwordx4 v[92:95], v10, s[20:23], s37 offen offset:1024 sc1
    buffer_load_dwordx4 v[100:103], v10, s[20:23], s37 offen offset:2048 sc1
    buffer_load_dwordx4 v[108:111], v10, s[20:23], s37 offen offset:3072 sc1
    buffer_load_dwordx4 v[48:51], v2, s[20:23], s36 offen offset:0 sc1
    buffer_load_dwordx4 v[56:59], v2, s[20:23], s36 offen offset:1024 sc1
    buffer_load_dwordx4 v[64:67], v2, s[20:23], s36 offen offset:2048 sc1
    buffer_load_dwordx4 v[72:75], v2, s[20:23], s36 offen offset:3072 sc1
    buffer_load_dwordx4 v[80:83], v10, s[20:23], s36 offen offset:0 sc1
    buffer_load_dwordx4 v[88:91], v10, s[20:23], s36 offen offset:1024 sc1
    buffer_load_dwordx4 v[96:99], v10, s[20:23], s36 offen offset:2048 sc1
    buffer_load_dwordx4 v[104:107], v10, s[20:23], s36 offen offset:3072 sc1
    s_mov_b32 s62, 40000
FC10:
    v_cmp_ne_u32 vcc, v248, v15
    s_nop 1
    s_and_b32 s4, vcc_lo, 7
    s_cbranch_scc0 FD10
    s_sub_u32 s62, s62, 1
    s_cbranch_scc1 FD10
    s_sleep 16
    s_mov_b64 exec, 7
    buffer_load_dword v248, v14, s[20:23], 0 offen sc1
    s_mov_b64 exec, -1
    s_waitcnt vmcnt(0)
    s_branch FC10
FD10:
    s_waitcnt vmcnt(15)
    v_mfma_f32_32x32x16_bf16 v[144:159], v[52:55], v[220:223], 0
    v_mfma_f32_32x32x16_bf16 v[128:143], v[52:55], v[216:219], 0
    s_waitcnt vmcnt(14)
    v_mfma_f32_32x32x16_bf16 v[144:159], v[60:63], v[164:167], v[144:159]
    v_mfma_f32_32x32x16_bf16 v[128:143], v[60:63], v[160:163], v[128:143]
    s_waitcnt vmcnt(13)
    v_mfma_f32_32x32x16_bf16 v[144:159], v[68:71], v[172:175], v[144:159]
    v_mfma_f32_32x32x16_bf16 v[128:143], v[68:71], v[168:171], v[128:143]
    s_waitcnt vmcnt(12)
    v_mfma_f32_32x32x16_bf16 v[144:159], v[76:79], v[180:183], v[144:159]
    v_mfma_f32_32x32x16_bf16 v[128:143], v[76:79], v[176:179], v[128:143]
    s_waitcnt vmcnt(11)
    v_mfma_f32_32x32x16_bf16 v[144:159], v[84:87], v[188:191], v[144:159]
    v_mfma_f32_32x32x16_bf16 v[128:143], v[84:87], v[184:187], v[128:143]
    s_waitcnt vmcnt(10)
    v_mfma_f32_32x32x16_bf16 v[144:159], v[92:95], v[196:199], v[144:159]
    buffer_load_dwordx4 v[232:235], v3, s[20:23], s39 offen offset:0 sc1
    v_mfma_f32_32x32x16_bf16 v[128:143], v[92:95], v[192:195], v[128:143]
    buffer_load_dwordx4 v[236:239], v3, s[20:23], s39 offen offset:512 sc1
    s_waitcnt vmcnt(11)
    v_mfma_f32_32x32x16_bf16 v[144:159], v[100:103], v[204:207], v[144:159]
    buffer_load_dwordx4 v[16:19], v12, s[20:23], s38 offen offset:0 sc1
    v_mfma_f32_32x32x16_bf16 v[128:143], v[100:103], v[200:203], v[128:143]
    buffer_load_dwordx4 v[20:23], v12, s[20:23], s38 offen offset:16 sc1
    s_waitcnt vmcnt(12)
    v_mfma_f32_32x32x16_bf16 v[144:159], v[108:111], v[212:215], v[144:159]
    buffer_load_dwordx4 v[24:27], v12, s[20:23], s38 offen offset:32 sc1
    v_mfma_f32_32x32x16_bf16 v[128:143], v[108:111], v[208:211], v[128:143]
    buffer_load_dwordx4 v[28:31], v12, s[20:23], s38 offen offset:48 sc1
    s_waitcnt vmcnt(13)
    v_mfma_f32_32x32x16_bf16 v[112:127], v[48:51], v[220:223], 0
    v_mfma_f32_32x32x16_bf16 v[32:47], v[48:51], v[216:219], 0
    s_waitcnt vmcnt(12)
    v_mfma_f32_32x32x16_bf16 v[112:127], v[56:59], v[164:167], v[112:127]
    v_mfma_f32_32x32x16_bf16 v[32:47], v[56:59], v[160:163], v[32:47]
    s_waitcnt vmcnt(11)
    v_mfma_f32_32x32x16_bf16 v[112:127], v[64:67], v[172:175], v[112:127]
    v_mfma_f32_32x32x16_bf16 v[32:47], v[64:67], v[168:171], v[32:47]
    s_waitcnt vmcnt(10)
    v_mfma_f32_32x32x16_bf16 v[112:127], v[72:75], v[180:183], v[112:127]
    v_mfma_f32_32x32x16_bf16 v[32:47], v[72:75], v[176:179], v[32:47]
    s_waitcnt vmcnt(9)
    v_mfma_f32_32x32x16_bf16 v[112:127], v[80:83], v[188:191], v[112:127]
    ds_write_b128 v6, v[144:147] offset:0
    v_mfma_f32_32x32x16_bf16 v[32:47], v[80:83], v[184:187], v[32:47]
    ds_write_b128 v6, v[148:151] offset:1024
    s_waitcnt vmcnt(8)
    v_mfma_f32_32x32x16_bf16 v[112:127], v[88:91], v[196:199], v[112:127]
    ds_write_b128 v6, v[152:155] offset:2048
    v_mfma_f32_32x32x16_bf16 v[32:47], v[88:91], v[192:195], v[32:47]
    ds_write_b128 v6, v[156:159] offset:3072
    s_waitcnt vmcnt(7)
    v_mfma_f32_32x32x16_bf16 v[112:127], v[96:99], v[204:207], v[112:127]
    ds_write_b128 v5, v[128:131] offset:0
    v_mfma_f32_32x32x16_bf16 v[32:47], v[96:99], v[200:203], v[32:47]
    ds_write_b128 v5, v[132:135] offset:1024
    s_waitcnt vmcnt(6)
    v_mfma_f32_32x32x16_bf16 v[112:127], v[104:107], v[212:215], v[112:127]
    ds_write_b128 v5, v[136:139] offset:2048
    v_mfma_f32_32x32x16_bf16 v[32:47], v[104:107], v[208:211], v[32:47]
    ds_write_b128 v5, v[140:143] offset:3072
    s_nop 8
    ds_write_b128 v4, v[112:115] offset:0
    ds_write_b128 v4, v[116:119] offset:1024
    ds_write_b128 v4, v[120:123] offset:2048
    ds_write_b128 v4, v[124:127] offset:3072
    s_waitcnt vmcnt(0)
    v_lshlrev_b32 v96, 16, v232
    v_and_b32 v97, 0xffff0000, v232
    v_lshlrev_b32 v98, 16, v233
    v_and_b32 v99, 0xffff0000, v233
    v_lshlrev_b32 v100, 16, v234
    v_and_b32 v101, 0xffff0000, v234
    v_lshlrev_b32 v102, 16, v235
    v_and_b32 v103, 0xffff0000, v235
    v_lshlrev_b32 v104, 16, v236
    v_and_b32 v105, 0xffff0000, v236
    v_lshlrev_b32 v106, 16, v237
    v_and_b32 v107, 0xffff0000, v237
    v_lshlrev_b32 v108, 16, v238
    v_and_b32 v109, 0xffff0000, v238
    v_lshlrev_b32 v110, 16, v239
    v_and_b32 v111, 0xffff0000, v239
    v_pk_add_f32 v[32:33], v[32:33], v[96:97] neg_lo:[0,1] neg_hi:[0,1]
    v_pk_add_f32 v[34:35], v[34:35], v[98:99] neg_lo:[0,1] neg_hi:[0,1]
    v_pk_add_f32 v[36:37], v[36:37], v[100:101] neg_lo:[0,1] neg_hi:[0,1]
    v_pk_add_f32 v[38:39], v[38:39], v[102:103] neg_lo:[0,1] neg_hi:[0,1]
    v_pk_add_f32 v[40:41], v[40:41], v[104:105] neg_lo:[0,1] neg_hi:[0,1]
    v_pk_add_f32 v[42:43], v[42:43], v[106:107] neg_lo:[0,1] neg_hi:[0,1]
    v_pk_add_f32 v[44:45], v[44:45], v[108:109] neg_lo:[0,1] neg_hi:[0,1]
    v_pk_add_f32 v[46:47], v[46:47], v[110:111] neg_lo:[0,1] neg_hi:[0,1]
    s_waitcnt lgkmcnt(0)
    s_barrier
    ds_read_b128 v[48:51], v7 offset:0
    ds_read_b128 v[52:55], v7 offset:1024
    ds_read_b128 v[56:59], v7 offset:2048
    ds_read_b128 v[60:63], v7 offset:3072
    ds_read_b128 v[64:67], v7 offset:4096
    ds_read_b128 v[68:71], v7 offset:5120
    ds_read_b128 v[72:75], v7 offset:6144
    ds_read_b128 v[76:79], v7 offset:7168
    ds_read_b128 v[80:83], v7 offset:8192
    ds_read_b128 v[84:87], v7 offset:9216
    ds_read_b128 v[88:91], v7 offset:10240
    ds_read_b128 v[92:95], v7 offset:11264
    s_waitcnt lgkmcnt(8)
    v_pk_add_f32 v[32:33], v[32:33], v[48:49]
    v_pk_add_f32 v[34:35], v[34:35], v[50:51]
    v_pk_add_f32 v[36:37], v[36:37], v[52:53]
    v_pk_add_f32 v[38:39], v[38:39], v[54:55]
    v_pk_add_f32 v[40:41], v[40:41], v[56:57]
    v_pk_add_f32 v[42:43], v[42:43], v[58:59]
    v_pk_add_f32 v[44:45], v[44:45], v[60:61]
    v_pk_add_f32 v[46:47], v[46:47], v[62:63]
    s_waitcnt lgkmcnt(4)
    v_pk_add_f32 v[32:33], v[32:33], v[64:65]
    v_pk_add_f32 v[34:35], v[34:35], v[66:67]
    v_pk_add_f32 v[36:37], v[36:37], v[68:69]
    v_pk_add_f32 v[38:39], v[38:39], v[70:71]
    v_pk_add_f32 v[40:41], v[40:41], v[72:73]
    v_pk_add_f32 v[42:43], v[42:43], v[74:75]
    v_pk_add_f32 v[44:45], v[44:45], v[76:77]
    v_pk_add_f32 v[46:47], v[46:47], v[78:79]
    s_waitcnt lgkmcnt(0)
    v_pk_add_f32 v[32:33], v[32:33], v[80:81]
    v_pk_add_f32 v[34:35], v[34:35], v[82:83]
    v_pk_add_f32 v[36:37], v[36:37], v[84:85]
    v_pk_add_f32 v[38:39], v[38:39], v[86:87]
    v_pk_add_f32 v[40:41], v[40:41], v[88:89]
    v_pk_add_f32 v[42:43], v[42:43], v[90:91]
    v_pk_add_f32 v[44:45], v[44:45], v[92:93]
    v_pk_add_f32 v[46:47], v[46:47], v[94:95]
    v_pk_fma_f32 v[32:33], v[32:33], v[16:17], v[96:97]
    v_pk_fma_f32 v[34:35], v[34:35], v[18:19], v[98:99]
    v_pk_fma_f32 v[36:37], v[36:37], v[20:21], v[100:101]
    v_pk_fma_f32 v[38:39], v[38:39], v[22:23], v[102:103]
    v_pk_fma_f32 v[40:41], v[40:41], v[24:25], v[104:105]
    v_pk_fma_f32 v[42:43], v[42:43], v[26:27], v[106:107]
    v_pk_fma_f32 v[44:45], v[44:45], v[28:29], v[108:109]
    v_pk_fma_f32 v[46:47], v[46:47], v[30:31], v[110:111]
    v_cvt_pk_bf16_f32 v48, v32, v33
    v_cvt_pk_bf16_f32 v49, v34, v35
    v_cvt_pk_bf16_f32 v50, v36, v37
    v_cvt_pk_bf16_f32 v51, v38, v39
    v_cvt_pk_bf16_f32 v52, v40, v41
    v_cvt_pk_bf16_f32 v53, v42, v43
    v_cvt_pk_bf16_f32 v54, v44, v45
    v_cvt_pk_bf16_f32 v55, v46, v47
    buffer_store_short v48, v9, s[12:15], s44 offen offset:0
    buffer_store_short_d16_hi v48, v9, s[12:15], s44 offen offset:896
    buffer_store_short v49, v9, s[12:15], s44 offen offset:1792
    buffer_store_short_d16_hi v49, v9, s[12:15], s44 offen offset:2688
    buffer_store_short v50, v9, s[12:15], s45 offen offset:0
    buffer_store_short_d16_hi v50, v9, s[12:15], s45 offen offset:896
    buffer_store_short v51, v9, s[12:15], s45 offen offset:1792
    buffer_store_short_d16_hi v51, v9, s[12:15], s45 offen offset:2688
    buffer_store_short v52, v9, s[12:15], s46 offen offset:0
    buffer_store_short_d16_hi v52, v9, s[12:15], s46 offen offset:896
    buffer_store_short v53, v9, s[12:15], s46 offen offset:1792
    buffer_store_short_d16_hi v53, v9, s[12:15], s46 offen offset:2688
    buffer_store_short v54, v9, s[12:15], s47 offen offset:0
    buffer_store_short_d16_hi v54, v9, s[12:15], s47 offen offset:896
    buffer_store_short v55, v9, s[12:15], s47 offen offset:1792
    buffer_store_short_d16_hi v55, v9, s[12:15], s47 offen offset:2688
A_XIT:
    s_endpgm
A_SLOW:
    s_mov_b32 s62, 40000
A_SLOW1:
    v_cmp_eq_u32 vcc, s58, v250
    s_nop 1
    s_and_b32 s5, vcc_lo, s63
    s_cmp_eq_u32 s5, s63
    s_cbranch_scc1 A_SLOW2
    s_mov_b64 exec, 15
    buffer_atomic_umax v250, v249, s[20:23], s53 offen sc0 sc1
    s_mov_b64 exec, -1
    s_cmp_lg_u32 s5, 0
    s_cbranch_scc1 A_SLOWR
    s_sub_u32 s62, s62, 1
    s_cbranch_scc1 A_SLOW2
    s_waitcnt vmcnt(0)
    s_branch A_SLOW1
A_SLOW2:
    s_or_b32 s5, s63, 128
    s_cmp_lg_u32 s63, 0
    s_cbranch_scc1 A_SLOWR
    v_readlane_b32 s4, v248, 2
    s_nop 1
    s_cmp_lg_u32 s4, 16
    s_cbranch_scc1 A_SLOWR
    v_mov_b32 v244, v10
    v_mov_b32 v245, v11
    v_mov_b32 v246, v12
    v_mov_b32 v247, v13
    s_lshl_b32 s4, s50, 15
    v_add_u32 v10, s4, v2
    v_xor_b32 v11, 32768, v10
    v_mov_b32 v12, v10
    v_mov_b32 v13, v11
    s_lshl_b32 s4, s24, 13
    s_add_u32 s6, s4, 3081216
    s_add_u32 s7, s4, 2683904
    s_add_u32 s12, s94, s6
    s_addc_u32 s13, s95, 0
    s_mov_b32 s14, 4194304
    s_mov_b32 s15, 0x00020000
    s_add_u32 s16, s94, s7
    s_addc_u32 s17, s95, 0
    s_mov_b32 s18, 4194304
    s_mov_b32 s19, 0x00020000
    s_movk_i32 s60, 1024
    s_movk_i32 s61, 1024
    s_branch A_SLOWR
A_LLOAD:
    s_mov_b64 exec, 7
    buffer_load_dword v248, v14, s[20:23], 0 offen sc1
    s_mov_b64 exec, -1
    s_branch A_LLOADR
A_FALLBACK:
    s_mov_b32 s41, -1
    s_cmp_lg_u32 s60, 1024
    s_cbranch_scc1 A_FB0
    v_mov_b32 v10, v244
    v_mov_b32 v11, v245
    v_mov_b32 v12, v246
    v_mov_b32 v13, v247
    s_mul_i32 s34, s24, 114688
    s_mul_i32 s37, s24, 129024
    s_add_u32 s37, s37, 2097152
    s_add_u32 s12, s94, s34
    s_addc_u32 s13, s95, 0
    s_mov_b32 s14, 1490944
    s_mov_b32 s15, 0x00020000
    s_add_u32 s16, s94, s37
    s_addc_u32 s17, s95, 0
    s_mov_b32 s18, 1677312
    s_mov_b32 s19, 0x00020000
A_FB0:
    v_mov_b32 v228, 0xff800000
    v_mov_b32 v229, 0xff800000
    v_mov_b32 v230, 0xff800000
    v_mov_b32 v231, 0xff800000
    s_mov_b32 s44, 0
    s_mov_b32 s45, 0
    s_waitcnt vmcnt(0) lgkmcnt(0)
A_FBLOOP:
    buffer_load_dwordx4 v[160:163], v10, s[12:15], s44 offen sc1
    buffer_load_dwordx4 v[164:167], v11, s[12:15], s44 offen sc1
    s_waitcnt vmcnt(0)
    v_mov_b32_dpp v166, v252 quad_perm:[0,1,2,3] row_mask:0xc bank_mask:0xf
    v_mov_b32_dpp v167, v253 quad_perm:[0,1,2,3] row_mask:0xc bank_mask:0xf
    s_nop 1
    v_mfma_f32_32x32x16_bf16 v[48:63], v[160:163], v[16:19], 0
    v_mfma_f32_32x32x16_bf16 v[48:63], v[164:167], v[20:23], v[48:63]
    v_mfma_f32_32x32x16_bf16 v[64:79], v[160:163], v[24:27], 0
    v_mfma_f32_32x32x16_bf16 v[64:79], v[164:167], v[28:31], v[64:79]
    v_mfma_f32_32x32x16_bf16 v[80:95], v[160:163], v[32:35], 0
    v_mfma_f32_32x32x16_bf16 v[80:95], v[164:167], v[36:39], v[80:95]
    v_mfma_f32_32x32x16_bf16 v[96:111], v[160:163], v[40:43], 0
    v_mfma_f32_32x32x16_bf16 v[96:111], v[164:167], v[44:47], v[96:111]
    s_nop 15
    v_max3_f32 v228, v228, v48, v49
    v_max3_f32 v229, v229, v64, v65
    v_max3_f32 v230, v230, v80, v81
    v_max3_f32 v231, v231, v96, v97
    v_max3_f32 v228, v228, v50, v51
    v_max3_f32 v229, v229, v66, v67
    v_max3_f32 v230, v230, v82, v83
    v_max3_f32 v231, v231, v98, v99
    v_max3_f32 v228, v228, v52, v53
    v_max3_f32 v229, v229, v68, v69
    v_max3_f32 v230, v230, v84, v85
    v_max3_f32 v231, v231, v100, v101
    v_max3_f32 v228, v228, v54, v55
    v_max3_f32 v229, v229, v70, v71
    v_max3_f32 v230, v230, v86, v87
    v_max3_f32 v231, v231, v102, v103
    v_max3_f32 v228, v228, v56, v57
    v_max3_f32 v229, v229, v72, v73
    v_max3_f32 v230, v230, v88, v89
    v_max3_f32 v231, v231, v104, v105
    v_max3_f32 v228, v228, v58, v59
    v_max3_f32 v229, v229, v74, v75
    v_max3_f32 v230, v230, v90, v91
    v_max3_f32 v231, v231, v106, v107
    v_max3_f32 v228, v228, v60, v61
    v_max3_f32 v229, v229, v76, v77
    v_max3_f32 v230, v230, v92, v93
    v_max3_f32 v231, v231, v108, v109
    v_max3_f32 v228, v228, v62, v63
    v_max3_f32 v229, v229, v78, v79
    v_max3_f32 v230, v230, v94, v95
    v_max3_f32 v231, v231, v110, v111
    s_addk_i32 s44, 28672
    s_add_u32 s45, s45, 1
    s_and_b32 s4, s45, 3
    s_cbranch_scc1 A_FBLOOP
    s_add_u32 s44, s44, 344064
    s_cmp_lt_u32 s45, 16
    s_cbranch_scc1 A_FBLOOP
    v_mov_b32 v232, v228
    v_mov_b32 v233, v229
    v_mov_b32 v234, v230
    v_mov_b32 v235, v231
    s_nop 1
    v_permlane32_swap_b32 v232, v228
    v_permlane32_swap_b32 v233, v229
    v_permlane32_swap_b32 v234, v230
    v_permlane32_swap_b32 v235, v231
    v_max_f32 v228, v228, v232
    v_max_f32 v229, v229, v233
    v_max_f32 v230, v230, v234
    v_max_f32 v231, v231, v235
    s_mov_b32 s59, 0
    s_mov_b32 s63, 14
    s_movk_i32 s5, 0x8e
    v_mov_b32 v250, s58
    v_mov_b32 v216, 0
    v_mov_b32 v217, 0
    v_mov_b32 v218, 0
    v_mov_b32 v219, 0
    v_mov_b32 v220, 0
    v_mov_b32 v221, 0
    v_mov_b32 v222, 0
    v_mov_b32 v223, 0
    s_mul_i32 s44, s59, 458752
    s_mul_i32 s45, s59, 516096
    buffer_load_dwordx4 v[160:163], v10, s[12:15], s44 offen sc1
    buffer_load_dwordx4 v[164:167], v11, s[12:15], s44 offen sc1
    s_addk_i32 s44, 28672
    buffer_load_dwordx4 v[192:195], v12, s[16:19], s45 offen sc1
    buffer_load_dwordx4 v[196:199], v13, s[16:19], s45 offen sc1
    s_addk_i32 s45, 32256
    buffer_load_dwordx4 v[168:171], v10, s[12:15], s44 offen sc1
    buffer_load_dwordx4 v[172:175], v11, s[12:15], s44 offen sc1
    s_addk_i32 s44, 28672
    buffer_load_dwordx4 v[200:203], v12, s[16:19], s45 offen sc1
    buffer_load_dwordx4 v[204:207], v13, s[16:19], s45 offen sc1
    s_addk_i32 s45, 32256
    buffer_load_dwordx4 v[176:179], v10, s[12:15], s44 offen sc1
    buffer_load_dwordx4 v[180:183], v11, s[12:15], s44 offen sc1
    s_addk_i32 s44, 28672
    buffer_load_dwordx4 v[208:211], v12, s[16:19], s45 offen sc1
    buffer_load_dwordx4 v[212:215], v13, s[16:19], s45 offen sc1
    s_addk_i32 s45, 32256
    buffer_load_dwordx4 v[184:187], v10, s[12:15], s44 offen sc1
    buffer_load_dwordx4 v[188:191], v11, s[12:15], s44 offen sc1
    v_mfma_f32_32x32x16_bf16 v[48:63], v[216:219], v[216:219], 0
    v_mfma_f32_32x32x16_bf16 v[64:79], v[216:219], v[216:219], 0
    v_mfma_f32_32x32x16_bf16 v[80:95], v[216:219], v[216:219], 0
    v_mfma_f32_32x32x16_bf16 v[96:111], v[216:219], v[216:219], 0
    s_waitcnt vmcnt(0)
    v_mov_b32_dpp v166, v252 quad_perm:[0,1,2,3] row_mask:0xc bank_mask:0xf
    v_mov_b32_dpp v167, v253 quad_perm:[0,1,2,3] row_mask:0xc bank_mask:0xf
    s_branch A_SETMAX
L_B:
    s_setprio 3
    s_mul_i32 s29, s24, 17408
    s_mov_b32 m0, s29
    v_mov_b32 v15, 0x3f80
    ds_write_addtid_b32 v15 offset:8704
    v_and_b32 v12, 1, v1
    v_lshlrev_b32 v12, 4, v12
    v_mov_b32 v15, 0x3f80
    v_lshlrev_b32 v12, v12, v15
    s_mov_b64 s[4:5], 3
    v_cndmask_b32 v16, 0, v12, s[4:5]
    s_lshl_b64 s[4:5], s[4:5], 2
    v_cndmask_b32 v17, 0, v12, s[4:5]
    s_lshl_b64 s[4:5], s[4:5], 2
    v_cndmask_b32 v18, 0, v12, s[4:5]
    s_lshl_b64 s[4:5], s[4:5], 2
    v_cndmask_b32 v19, 0, v12, s[4:5]
    s_lshl_b64 s[4:5], s[4:5], 2
    v_cndmask_b32 v20, 0, v12, s[4:5]
    s_lshl_b64 s[4:5], s[4:5], 2
    v_cndmask_b32 v21, 0, v12, s[4:5]
    s_lshl_b64 s[4:5], s[4:5], 2
    v_cndmask_b32 v22, 0, v12, s[4:5]
    s_lshl_b64 s[4:5], s[4:5], 2
    v_cndmask_b32 v23, 0, v12, s[4:5]
    s_lshl_b64 s[4:5], s[4:5], 2
    v_cndmask_b32 v24, 0, v12, s[4:5]
    s_lshl_b64 s[4:5], s[4:5], 2
    v_cndmask_b32 v25, 0, v12, s[4:5]
    s_lshl_b64 s[4:5], s[4:5], 2
    v_cndmask_b32 v26, 0, v12, s[4:5]
    s_lshl_b64 s[4:5], s[4:5], 2
    v_cndmask_b32 v27, 0, v12, s[4:5]
    s_lshl_b64 s[4:5], s[4:5], 2
    v_cndmask_b32 v28, 0, v12, s[4:5]
    s_lshl_b64 s[4:5], s[4:5], 2
    v_cndmask_b32 v29, 0, v12, s[4:5]
    s_lshl_b64 s[4:5], s[4:5], 2
    v_cndmask_b32 v30, 0, v12, s[4:5]
    s_lshl_b64 s[4:5], s[4:5], 2
    v_cndmask_b32 v31, 0, v12, s[4:5]
    s_lshl_b64 s[4:5], s[4:5], 2
    v_cndmask_b32 v32, 0, v12, s[4:5]
    s_lshl_b64 s[4:5], s[4:5], 2
    v_cndmask_b32 v33, 0, v12, s[4:5]
    s_lshl_b64 s[4:5], s[4:5], 2
    v_cndmask_b32 v34, 0, v12, s[4:5]
    s_lshl_b64 s[4:5], s[4:5], 2
    v_cndmask_b32 v35, 0, v12, s[4:5]
    s_lshl_b64 s[4:5], s[4:5], 2
    v_cndmask_b32 v36, 0, v12, s[4:5]
    s_lshl_b64 s[4:5], s[4:5], 2
    v_cndmask_b32 v37, 0, v12, s[4:5]
    s_lshl_b64 s[4:5], s[4:5], 2
    v_cndmask_b32 v38, 0, v12, s[4:5]
    s_lshl_b64 s[4:5], s[4:5], 2
    v_cndmask_b32 v39, 0, v12, s[4:5]
    s_lshl_b64 s[4:5], s[4:5], 2
    v_cndmask_b32 v40, 0, v12, s[4:5]
    s_lshl_b64 s[4:5], s[4:5], 2
    v_cndmask_b32 v41, 0, v12, s[4:5]
    s_lshl_b64 s[4:5], s[4:5], 2
    v_cndmask_b32 v42, 0, v12, s[4:5]
    s_lshl_b64 s[4:5], s[4:5], 2
    v_cndmask_b32 v43, 0, v12, s[4:5]
    s_lshl_b64 s[4:5], s[4:5], 2
    v_cndmask_b32 v44, 0, v12, s[4:5]
    s_lshl_b64 s[4:5], s[4:5], 2
    v_cndmask_b32 v45, 0, v12, s[4:5]
    s_lshl_b64 s[4:5], s[4:5], 2
    v_cndmask_b32 v46, 0, v12, s[4:5]
    s_lshl_b64 s[4:5], s[4:5], 2
    v_cndmask_b32 v47, 0, v12, s[4:5]
    v_lshrrev_b32 v13, 5, v1
    v_mov_b32 v176, 0
    v_mov_b32 v177, 0
    v_mov_b32 v178, 0
    v_mov_b32 v179, 0
    v_mul_u32_u24 v12, 4096, v13
    v_add_u32 v12, v12, v2
    v_add_u32 v12, 69632, v12
    ds_write_b128 v12, v[176:179]
    s_lshl_b32 s42, s24, 3
    s_add_u32 s42, s42, s31
    s_lshl_b32 s42, s42, 7
    s_add_u32 s42, s42, 6799360
    v_lshrrev_b32 v12, 1, v1
    v_and_b32 v13, 1, v1
    v_mul_u32_u24 v3, 7296, v12
    v_lshl_add_u32 v3, v13, 4, v3
    s_mul_i32 s43, s24, 466944
    s_mul_i32 s33, s31, 896
    s_add_u32 s43, s43, s33
    s_lshl_b32 s33, s39, 4
    s_add_u32 s43, s43, s33
    s_add_u32 s43, s43, 4194304
    s_add_u32 s44, s43, 233472
    v_mul_u32_u24 v241, 4608, v13
    v_lshl_add_u32 v241, v12, 4, v241
    s_lshl_b32 s33, s24, 10
    s_add_u32 s33, s33, 70144
    v_add_u32 v241, s33, v241
    s_waitcnt lgkmcnt(0)
    s_and_b32 s33, s26, 1
    s_lshl_b32 s33, s33, 4
    s_lshr_b32 s28, s28, s33
    s_lshl_b32 s28, s28, 16
    s_lshr_b32 s38, s38, s33
    s_lshl_b32 s38, s38, 16
    v_mov_b32 v13, 0x3fb8aa3b
    v_mul_f32 v14, s28, v13
    v_fma_f32 v13, s28, v13, -v14
    v_mov_b32 v15, 0x32a57060
    v_fmac_f32 v13, s28, v15
    v_exp_f32 v14, v14
    v_mul_f32 v13, 0x3f317218, v13
    v_fmac_f32 v14, v14, v13
    v_cvt_pk_bf16_f32 v14, v14, v14
    v_and_b32 v14, 0xffff0000, v14
    s_mov_b32 s48, 0x3fb8aa3b
    s_mov_b32 s49, 0x3e22f983
    s_mov_b32 s47, 0x07060302
    s_brev_b32 s46, 1
    s_cmp_ge_u32 s2, 2
    s_cbranch_scc1 B_NORDY
    v_mov_b32 v4, 1
    s_setprio 3
    s_waitcnt vmcnt(6)
    s_mov_b64 exec, 1
    global_atomic_add v255, v4, s[92:93] sc1
    s_mov_b64 exec, -1
    s_setprio 3
B_NORDY:
    s_waitcnt vmcnt(4)
    v_lshlrev_b32 v8, 16, v244
    v_lshlrev_b32 v9, 16, v245
    v_pk_mul_f32 v[8:9], v[8:9], v[14:15] op_sel_hi:[1,0]
    v_pk_mul_f32 v[8:9], v[8:9], s[48:49]
    v_mul_f32 v4, 0x41000000, v8
    v_mul_f32 v5, 0x41000000, v9
    v_mul_f32 v6, 0x43800000, v8
    v_mul_f32 v7, 0x43800000, v9
    v_fract_f32 v5, v5
    v_exp_f32 v4, v4
    v_fract_f32 v9, v9
    v_exp_f32 v8, v8
    v_fract_f32 v7, v7
    v_exp_f32 v6, v6
    v_cos_f32 v50, v5
    v_sin_f32 v51, v5
    v_cos_f32 v238, v9
    v_sin_f32 v239, v9
    v_cos_f32 v242, v7
    v_sin_f32 v243, v7
    s_nop 0
    v_pk_mul_f32 v[50:51], v[50:51], v[4:5] op_sel_hi:[1,0]
    v_pk_mul_f32 v[238:239], v[238:239], v[8:9] op_sel_hi:[1,0]
    v_pk_mul_f32 v[242:243], v[242:243], v[6:7] op_sel_hi:[1,0]
    v_pk_mul_f32 v[52:53], v[50:51], v[50:51] op_sel_hi:[0,1]
    v_cvt_pk_bf16_f32 v192, v50, v51
    v_pk_fma_f32 v[52:53], v[50:51], v[50:51], v[52:53] op_sel:[1,1,0] op_sel_hi:[1,0,1] neg_lo:[1,0,0]
    v_pk_mul_f32 v[54:55], v[52:53], v[50:51] op_sel_hi:[0,1]
    v_pk_mul_f32 v[56:57], v[52:53], v[52:53] op_sel_hi:[0,1]
    v_cvt_pk_bf16_f32 v193, v52, v53
    v_pk_fma_f32 v[54:55], v[52:53], v[50:51], v[54:55] op_sel:[1,1,0] op_sel_hi:[1,0,1] neg_lo:[1,0,0]
    v_pk_fma_f32 v[56:57], v[52:53], v[52:53], v[56:57] op_sel:[1,1,0] op_sel_hi:[1,0,1] neg_lo:[1,0,0]
    v_pk_mul_f32 v[64:65], v[56:57], v[56:57] op_sel_hi:[0,1]
    v_pk_mul_f32 v[58:59], v[56:57], v[50:51] op_sel_hi:[0,1]
    v_pk_mul_f32 v[60:61], v[56:57], v[52:53] op_sel_hi:[0,1]
    v_pk_mul_f32 v[62:63], v[56:57], v[54:55] op_sel_hi:[0,1]
    v_cvt_pk_bf16_f32 v194, v54, v55
    v_cvt_pk_bf16_f32 v195, v56, v57
    v_pk_fma_f32 v[64:65], v[56:57], v[56:57], v[64:65] op_sel:[1,1,0] op_sel_hi:[1,0,1] neg_lo:[1,0,0]
    v_pk_fma_f32 v[58:59], v[56:57], v[50:51], v[58:59] op_sel:[1,1,0] op_sel_hi:[1,0,1] neg_lo:[1,0,0]
    v_pk_fma_f32 v[60:61], v[56:57], v[52:53], v[60:61] op_sel:[1,1,0] op_sel_hi:[1,0,1] neg_lo:[1,0,0]
    v_pk_fma_f32 v[62:63], v[56:57], v[54:55], v[62:63] op_sel:[1,1,0] op_sel_hi:[1,0,1] neg_lo:[1,0,0]
    v_pk_mul_f32 v[80:81], v[64:65], v[64:65] op_sel_hi:[0,1]
    v_pk_mul_f32 v[66:67], v[64:65], v[50:51] op_sel_hi:[0,1]
    v_pk_mul_f32 v[68:69], v[64:65], v[52:53] op_sel_hi:[0,1]
    v_pk_mul_f32 v[70:71], v[64:65], v[54:55] op_sel_hi:[0,1]
    v_cvt_pk_bf16_f32 v196, v64, v65
    v_cvt_pk_bf16_f32 v197, v58, v59
    v_pk_fma_f32 v[80:81], v[64:65], v[64:65], v[80:81] op_sel:[1,1,0] op_sel_hi:[1,0,1] neg_lo:[1,0,0]
    v_pk_fma_f32 v[66:67], v[64:65], v[50:51], v[66:67] op_sel:[1,1,0] op_sel_hi:[1,0,1] neg_lo:[1,0,0]
    v_pk_fma_f32 v[68:69], v[64:65], v[52:53], v[68:69] op_sel:[1,1,0] op_sel_hi:[1,0,1] neg_lo:[1,0,0]
    v_pk_fma_f32 v[70:71], v[64:65], v[54:55], v[70:71] op_sel:[1,1,0] op_sel_hi:[1,0,1] neg_lo:[1,0,0]
    v_cvt_pk_bf16_f32 v198, v60, v61
    v_cvt_pk_bf16_f32 v199, v62, v63
    v_pk_mul_f32 v[72:73], v[64:65], v[56:57] op_sel_hi:[0,1]
    v_pk_mul_f32 v[74:75], v[64:65], v[58:59] op_sel_hi:[0,1]
    v_pk_mul_f32 v[76:77], v[64:65], v[60:61] op_sel_hi:[0,1]
    v_pk_mul_f32 v[78:79], v[64:65], v[62:63] op_sel_hi:[0,1]
    v_cvt_pk_bf16_f32 v200, v80, v81
    v_cvt_pk_bf16_f32 v201, v66, v67
    v_pk_fma_f32 v[72:73], v[64:65], v[56:57], v[72:73] op_sel:[1,1,0] op_sel_hi:[1,0,1] neg_lo:[1,0,0]
    v_pk_fma_f32 v[74:75], v[64:65], v[58:59], v[74:75] op_sel:[1,1,0] op_sel_hi:[1,0,1] neg_lo:[1,0,0]
    v_pk_fma_f32 v[76:77], v[64:65], v[60:61], v[76:77] op_sel:[1,1,0] op_sel_hi:[1,0,1] neg_lo:[1,0,0]
    v_pk_fma_f32 v[78:79], v[64:65], v[62:63], v[78:79] op_sel:[1,1,0] op_sel_hi:[1,0,1] neg_lo:[1,0,0]
    v_cvt_pk_bf16_f32 v202, v68, v69
    v_cvt_pk_bf16_f32 v203, v70, v71
    v_pk_mul_f32 v[82:83], v[80:81], v[50:51] op_sel_hi:[0,1]
    v_pk_mul_f32 v[84:85], v[80:81], v[52:53] op_sel_hi:[0,1]
    v_pk_mul_f32 v[86:87], v[80:81], v[54:55] op_sel_hi:[0,1]
    v_pk_mul_f32 v[88:89], v[80:81], v[56:57] op_sel_hi:[0,1]
    v_cvt_pk_bf16_f32 v204, v72, v73
    v_cvt_pk_bf16_f32 v205, v74, v75
    v_pk_fma_f32 v[82:83], v[80:81], v[50:51], v[82:83] op_sel:[1,1,0] op_sel_hi:[1,0,1] neg_lo:[1,0,0]
    v_pk_fma_f32 v[84:85], v[80:81], v[52:53], v[84:85] op_sel:[1,1,0] op_sel_hi:[1,0,1] neg_lo:[1,0,0]
    v_pk_fma_f32 v[86:87], v[80:81], v[54:55], v[86:87] op_sel:[1,1,0] op_sel_hi:[1,0,1] neg_lo:[1,0,0]
    v_pk_fma_f32 v[88:89], v[80:81], v[56:57], v[88:89] op_sel:[1,1,0] op_sel_hi:[1,0,1] neg_lo:[1,0,0]
    v_cvt_pk_bf16_f32 v206, v76, v77
    v_cvt_pk_bf16_f32 v207, v78, v79
    ds_write_addtid_b32 v192 offset:8976
    ds_write_addtid_b32 v193 offset:9248
    ds_write_addtid_b32 v194 offset:9520
    ds_write_addtid_b32 v195 offset:9792
    ds_write_addtid_b32 v196 offset:10880
    ds_write_addtid_b32 v197 offset:10064
    ds_write_addtid_b32 v198 offset:10336
    ds_write_addtid_b32 v199 offset:10608
    ds_write_addtid_b32 v200 offset:13056
    ds_write_addtid_b32 v201 offset:11152
    ds_write_addtid_b32 v202 offset:11424
    ds_write_addtid_b32 v203 offset:11696
    ds_write_addtid_b32 v204 offset:11968
    ds_write_addtid_b32 v205 offset:12240
    ds_write_addtid_b32 v206 offset:12512
    ds_write_addtid_b32 v207 offset:12784
    s_waitcnt vmcnt(0)
    v_lshlrev_b32 v10, 16, v246
    v_lshlrev_b32 v11, 16, v247
    v_lshlrev_b32 v12, 16, v248
    v_lshlrev_b32 v13, 16, v249
    v_pk_mul_f32 v[112:113], v[12:13], v[10:11] op_sel_hi:[0,1]
    v_pk_fma_f32 v[112:113], v[12:13], v[10:11], v[112:113] op_sel:[1,1,0] op_sel_hi:[1,0,1] neg_lo:[1,0,0]
    v_pk_mul_f32 v[112:113], v[112:113], v[14:15] op_sel_hi:[1,0]
    v_pk_mul_f32 v[128:129], v[112:113], v[50:51] op_sel_hi:[0,1]
    v_pk_mul_f32 v[114:115], v[112:113], v[238:239] op_sel_hi:[0,1]
    v_pk_mul_f32 v[130:131], v[112:113], v[242:243] op_sel_hi:[0,1]
    v_pk_mul_f32 v[90:91], v[80:81], v[58:59] op_sel_hi:[0,1]
    v_cvt_pk_bf16_f32 v208, v82, v83
    v_cvt_pk_bf16_f32 v209, v84, v85
    v_pk_fma_f32 v[128:129], v[112:113], v[50:51], v[128:129] op_sel:[1,1,0] op_sel_hi:[1,0,1] neg_lo:[1,0,0]
    v_pk_fma_f32 v[114:115], v[112:113], v[238:239], v[114:115] op_sel:[1,1,0] op_sel_hi:[1,0,1] neg_lo:[1,0,0]
    v_pk_fma_f32 v[130:131], v[112:113], v[242:243], v[130:131] op_sel:[1,1,0] op_sel_hi:[1,0,1] neg_lo:[1,0,0]
    v_pk_fma_f32 v[90:91], v[80:81], v[58:59], v[90:91] op_sel:[1,1,0] op_sel_hi:[1,0,1] neg_lo:[1,0,0]
    v_cvt_pk_bf16_f32 v210, v86, v87
    v_cvt_pk_bf16_f32 v211, v88, v89
    v_cvt_pk_bf16_f32 v212, v112, -v113
    v_pk_mul_f32 v[138:139], v[128:129], v[242:243] op_sel_hi:[0,1]
    v_pk_mul_f32 v[116:117], v[114:115], v[238:239] op_sel_hi:[0,1]
    v_pk_mul_f32 v[140:141], v[130:131], v[242:243] op_sel_hi:[0,1]
    v_pk_mul_f32 v[92:93], v[80:81], v[60:61] op_sel_hi:[0,1]
    v_cvt_pk_bf16_f32 v213, v128, -v129
    v_cvt_pk_bf16_f32 v214, v114, -v115
    v_pk_fma_f32 v[138:139], v[128:129], v[242:243], v[138:139] op_sel:[1,1,0] op_sel_hi:[1,0,1] neg_lo:[1,0,0]
    v_pk_fma_f32 v[116:117], v[114:115], v[238:239], v[116:117] op_sel:[1,1,0] op_sel_hi:[1,0,1] neg_lo:[1,0,0]
    v_pk_fma_f32 v[140:141], v[130:131], v[242:243], v[140:141] op_sel:[1,1,0] op_sel_hi:[1,0,1] neg_lo:[1,0,0]
    v_pk_fma_f32 v[92:93], v[80:81], v[60:61], v[92:93] op_sel:[1,1,0] op_sel_hi:[1,0,1] neg_lo:[1,0,0]
    v_cvt_pk_bf16_f32 v215, v130, -v131
    v_cvt_pk_bf16_f32 v216, v90, v91
    v_pk_mul_f32 v[144:145], v[138:139], v[242:243] op_sel_hi:[0,1]
    v_pk_mul_f32 v[118:119], v[116:117], v[238:239] op_sel_hi:[0,1]
    v_pk_mul_f32 v[146:147], v[140:141], v[242:243] op_sel_hi:[0,1]
    v_pk_mul_f32 v[132:133], v[116:117], v[242:243] op_sel_hi:[0,1]
    v_cvt_pk_bf16_f32 v217, v138, -v139
    v_cvt_pk_bf16_f32 v218, v116, -v117
    v_pk_fma_f32 v[144:145], v[138:139], v[242:243], v[144:145] op_sel:[1,1,0] op_sel_hi:[1,0,1] neg_lo:[1,0,0]
    v_pk_fma_f32 v[118:119], v[116:117], v[238:239], v[118:119] op_sel:[1,1,0] op_sel_hi:[1,0,1] neg_lo:[1,0,0]
    v_pk_fma_f32 v[146:147], v[140:141], v[242:243], v[146:147] op_sel:[1,1,0] op_sel_hi:[1,0,1] neg_lo:[1,0,0]
    v_pk_fma_f32 v[132:133], v[116:117], v[242:243], v[132:133] op_sel:[1,1,0] op_sel_hi:[1,0,1] neg_lo:[1,0,0]
    v_cvt_pk_bf16_f32 v219, v140, -v141
    v_cvt_pk_bf16_f32 v220, v92, v93
    v_pk_mul_f32 v[150:151], v[144:145], v[242:243] op_sel_hi:[0,1]
    v_pk_mul_f32 v[120:121], v[118:119], v[238:239] op_sel_hi:[0,1]
    v_pk_mul_f32 v[152:153], v[146:147], v[242:243] op_sel_hi:[0,1]
    v_pk_mul_f32 v[94:95], v[80:81], v[62:63] op_sel_hi:[0,1]
    v_cvt_pk_bf16_f32 v221, v144, -v145
    v_cvt_pk_bf16_f32 v222, v118, -v119
    v_pk_fma_f32 v[150:151], v[144:145], v[242:243], v[150:151] op_sel:[1,1,0] op_sel_hi:[1,0,1] neg_lo:[1,0,0]
    v_pk_fma_f32 v[120:121], v[118:119], v[238:239], v[120:121] op_sel:[1,1,0] op_sel_hi:[1,0,1] neg_lo:[1,0,0]
    v_pk_fma_f32 v[152:153], v[146:147], v[242:243], v[152:153] op_sel:[1,1,0] op_sel_hi:[1,0,1] neg_lo:[1,0,0]
    v_pk_fma_f32 v[94:95], v[80:81], v[62:63], v[94:95] op_sel:[1,1,0] op_sel_hi:[1,0,1] neg_lo:[1,0,0]
    v_cvt_pk_bf16_f32 v223, v146, -v147
    ds_write_addtid_b32 v208 offset:13328
    ds_write_addtid_b32 v209 offset:13600
    ds_write_addtid_b32 v210 offset:13872
    ds_write_addtid_b32 v211 offset:14144
    ds_write_addtid_b32 v212 offset:0
    ds_write_addtid_b32 v213 offset:4352
    ds_write_addtid_b32 v214 offset:272
    ds_write_addtid_b32 v215 offset:1088
    ds_write_addtid_b32 v216 offset:14416
    ds_write_addtid_b32 v217 offset:4080
    ds_write_addtid_b32 v218 offset:544
    ds_write_addtid_b32 v219 offset:4624
    ds_write_addtid_b32 v220 offset:14688
    ds_write_addtid_b32 v221 offset:5168
    ds_write_addtid_b32 v222 offset:816
    ds_write_addtid_b32 v223 offset:5712
    v_cvt_pk_bf16_f32 v192, v132, -v133
    v_pk_mul_f32 v[154:155], v[150:151], v[242:243] op_sel_hi:[0,1]
    v_pk_mul_f32 v[122:123], v[120:121], v[238:239] op_sel_hi:[0,1]
    v_pk_mul_f32 v[134:135], v[120:121], v[242:243] op_sel_hi:[0,1]
    v_pk_mul_f32 v[156:157], v[152:153], v[242:243] op_sel_hi:[0,1]
    v_cvt_pk_bf16_f32 v193, v150, -v151
    v_cvt_pk_bf16_f32 v194, v120, -v121
    v_pk_fma_f32 v[154:155], v[150:151], v[242:243], v[154:155] op_sel:[1,1,0] op_sel_hi:[1,0,1] neg_lo:[1,0,0]
    v_pk_fma_f32 v[122:123], v[120:121], v[238:239], v[122:123] op_sel:[1,1,0] op_sel_hi:[1,0,1] neg_lo:[1,0,0]
    v_pk_fma_f32 v[134:135], v[120:121], v[242:243], v[134:135] op_sel:[1,1,0] op_sel_hi:[1,0,1] neg_lo:[1,0,0]
    v_pk_fma_f32 v[156:157], v[152:153], v[242:243], v[156:157] op_sel:[1,1,0] op_sel_hi:[1,0,1] neg_lo:[1,0,0]
    v_cvt_pk_bf16_f32 v195, v152, -v153
    v_cvt_pk_bf16_f32 v196, v94, v95
    v_pk_mul_f32 v[158:159], v[154:155], v[242:243] op_sel_hi:[0,1]
    v_pk_mul_f32 v[124:125], v[122:123], v[238:239] op_sel_hi:[0,1]
    v_pk_mul_f32 v[142:143], v[134:135], v[242:243] op_sel_hi:[0,1]
    v_pk_mul_f32 v[160:161], v[156:157], v[242:243] op_sel_hi:[0,1]
    v_cvt_pk_bf16_f32 v197, v154, -v155
    v_cvt_pk_bf16_f32 v198, v122, -v123
    v_pk_fma_f32 v[158:159], v[154:155], v[242:243], v[158:159] op_sel:[1,1,0] op_sel_hi:[1,0,1] neg_lo:[1,0,0]
    v_pk_fma_f32 v[124:125], v[122:123], v[238:239], v[124:125] op_sel:[1,1,0] op_sel_hi:[1,0,1] neg_lo:[1,0,0]
    v_pk_fma_f32 v[142:143], v[134:135], v[242:243], v[142:143] op_sel:[1,1,0] op_sel_hi:[1,0,1] neg_lo:[1,0,0]
    v_pk_fma_f32 v[160:161], v[156:157], v[242:243], v[160:161] op_sel:[1,1,0] op_sel_hi:[1,0,1] neg_lo:[1,0,0]
    v_cvt_pk_bf16_f32 v199, v134, -v135
    v_cvt_pk_bf16_f32 v200, v156, -v157
    v_pk_mul_f32 v[162:163], v[158:159], v[242:243] op_sel_hi:[0,1]
    v_pk_mul_f32 v[126:127], v[124:125], v[238:239] op_sel_hi:[0,1]
    v_pk_mul_f32 v[136:137], v[124:125], v[242:243] op_sel_hi:[0,1]
    v_pk_mul_f32 v[148:149], v[142:143], v[242:243] op_sel_hi:[0,1]
    v_cvt_pk_bf16_f32 v201, v158, -v159
    v_cvt_pk_bf16_f32 v202, v124, -v125
    v_pk_fma_f32 v[162:163], v[158:159], v[242:243], v[162:163] op_sel:[1,1,0] op_sel_hi:[1,0,1] neg_lo:[1,0,0]
    v_pk_fma_f32 v[126:127], v[124:125], v[238:239], v[126:127] op_sel:[1,1,0] op_sel_hi:[1,0,1] neg_lo:[1,0,0]
    v_pk_fma_f32 v[136:137], v[124:125], v[242:243], v[136:137] op_sel:[1,1,0] op_sel_hi:[1,0,1] neg_lo:[1,0,0]
    v_pk_fma_f32 v[148:149], v[142:143], v[242:243], v[148:149] op_sel:[1,1,0] op_sel_hi:[1,0,1] neg_lo:[1,0,0]
    v_cvt_pk_bf16_f32 v203, v142, -v143
    v_cvt_pk_bf16_f32 v204, v160, -v161
    v_pk_mul_f32 v[164:165], v[160:161], v[242:243] op_sel_hi:[0,1]
    v_pk_mul_f32 v[166:167], v[162:163], v[242:243] op_sel_hi:[0,1]
    v_pk_mul_f32 v[96:97], v[80:81], v[64:65] op_sel_hi:[0,1]
    v_pk_mul_f32 v[98:99], v[80:81], v[66:67] op_sel_hi:[0,1]
    v_cvt_pk_bf16_f32 v205, v162, -v163
    v_cvt_pk_bf16_f32 v206, v126, -v127
    v_pk_fma_f32 v[164:165], v[160:161], v[242:243], v[164:165] op_sel:[1,1,0] op_sel_hi:[1,0,1] neg_lo:[1,0,0]
    v_pk_fma_f32 v[166:167], v[162:163], v[242:243], v[166:167] op_sel:[1,1,0] op_sel_hi:[1,0,1] neg_lo:[1,0,0]
    v_pk_fma_f32 v[96:97], v[80:81], v[64:65], v[96:97] op_sel:[1,1,0] op_sel_hi:[1,0,1] neg_lo:[1,0,0]
    v_pk_fma_f32 v[98:99], v[80:81], v[66:67], v[98:99] op_sel:[1,1,0] op_sel_hi:[1,0,1] neg_lo:[1,0,0]
    v_cvt_pk_bf16_f32 v207, v136, -v137
    ds_write_addtid_b32 v192 offset:1632
    ds_write_addtid_b32 v193 offset:6256
    ds_write_addtid_b32 v194 offset:2176
    ds_write_addtid_b32 v195 offset:6528
    ds_write_addtid_b32 v196 offset:14960
    ds_write_addtid_b32 v197 offset:6800
    ds_write_addtid_b32 v198 offset:2448
    ds_write_addtid_b32 v199 offset:1904
    ds_write_addtid_b32 v200 offset:7616
    ds_write_addtid_b32 v201 offset:7888
    ds_write_addtid_b32 v202 offset:2720
    ds_write_addtid_b32 v203 offset:4896
    ds_write_addtid_b32 v204 offset:7072
    ds_write_addtid_b32 v205 offset:7344
    ds_write_addtid_b32 v206 offset:2992
    ds_write_addtid_b32 v207 offset:3808
    v_cvt_pk_bf16_f32 v208, v148, -v149
    v_pk_mul_f32 v[100:101], v[80:81], v[68:69] op_sel_hi:[0,1]
    v_pk_mul_f32 v[102:103], v[80:81], v[70:71] op_sel_hi:[0,1]
    v_pk_mul_f32 v[104:105], v[80:81], v[72:73] op_sel_hi:[0,1]
    v_pk_mul_f32 v[106:107], v[80:81], v[74:75] op_sel_hi:[0,1]
    v_cvt_pk_bf16_f32 v209, v164, -v165
    v_cvt_pk_bf16_f32 v210, v166, -v167
    v_pk_fma_f32 v[100:101], v[80:81], v[68:69], v[100:101] op_sel:[1,1,0] op_sel_hi:[1,0,1] neg_lo:[1,0,0]
    v_pk_fma_f32 v[102:103], v[80:81], v[70:71], v[102:103] op_sel:[1,1,0] op_sel_hi:[1,0,1] neg_lo:[1,0,0]
    v_pk_fma_f32 v[104:105], v[80:81], v[72:73], v[104:105] op_sel:[1,1,0] op_sel_hi:[1,0,1] neg_lo:[1,0,0]
    v_pk_fma_f32 v[106:107], v[80:81], v[74:75], v[106:107] op_sel:[1,1,0] op_sel_hi:[1,0,1] neg_lo:[1,0,0]
    v_cvt_pk_bf16_f32 v211, v96, v97
    v_cvt_pk_bf16_f32 v212, v98, v99
    v_pk_mul_f32 v[108:109], v[80:81], v[76:77] op_sel_hi:[0,1]
    v_pk_mul_f32 v[110:111], v[80:81], v[78:79] op_sel_hi:[0,1]
    v_cvt_pk_bf16_f32 v213, v100, v101
    v_cvt_pk_bf16_f32 v214, v102, v103
    v_pk_fma_f32 v[108:109], v[80:81], v[76:77], v[108:109] op_sel:[1,1,0] op_sel_hi:[1,0,1] neg_lo:[1,0,0]
    v_pk_fma_f32 v[110:111], v[80:81], v[78:79], v[110:111] op_sel:[1,1,0] op_sel_hi:[1,0,1] neg_lo:[1,0,0]
    v_cvt_pk_bf16_f32 v215, v104, v105
    v_cvt_pk_bf16_f32 v216, v106, v107
    v_cvt_pk_bf16_f32 v217, v108, v109
    v_cvt_pk_bf16_f32 v218, v110, v111
    ds_write_addtid_b32 v208 offset:5984
    ds_write_addtid_b32 v209 offset:8160
    ds_write_addtid_b32 v210 offset:8432
    ds_write_addtid_b32 v211 offset:15232
    ds_write_addtid_b32 v212 offset:15504
    ds_write_addtid_b32 v213 offset:15776
    ds_write_addtid_b32 v214 offset:16048
    ds_write_addtid_b32 v215 offset:16320
    ds_write_addtid_b32 v216 offset:16592
    ds_write_addtid_b32 v217 offset:16864
    ds_write_addtid_b32 v218 offset:17136
    s_setprio 3
    s_mov_b32 s45, 0
    v_and_b32 v8, 0xffff0000, v244
    v_and_b32 v9, 0xffff0000, v245
    v_mul_f32 v8, v8, v14
    v_mul_f32 v9, v9, v14
    v_mul_f32 v8, s48, v8
    v_mul_f32 v9, s49, v9
    v_mul_f32 v4, 0x41000000, v8
    v_mul_f32 v5, 0x41000000, v9
    v_mul_f32 v6, 0x43800000, v8
    v_mul_f32 v7, 0x43800000, v9
    v_fract_f32 v5, v5
    v_exp_f32 v4, v4
    v_fract_f32 v9, v9
    v_exp_f32 v8, v8
    v_fract_f32 v7, v7
    v_exp_f32 v6, v6
    v_cos_f32 v236, v5
    v_sin_f32 v237, v5
    v_cos_f32 v238, v9
    v_sin_f32 v239, v9
    v_cos_f32 v242, v7
    v_sin_f32 v243, v7
    s_nop 0
    v_mul_f32 v236, v236, v4
    v_mul_f32 v237, v237, v4
    v_mul_f32 v238, v238, v8
    v_mul_f32 v239, v239, v8
    v_mul_f32 v242, v242, v6
    v_mul_f32 v243, v243, v6
    v_xor_b32 v240, s46, v237
    v_xor_b32 v15, s46, v243
    v_mul_f32 v146, v236, v236
    v_mul_f32 v147, v236, v237
    v_fmac_f32 v146, v237, v240
    v_fmac_f32 v147, v237, v236
    v_xor_b32 v251, s46, v147
    v_cvt_pk_bf16_f32 v112, 1.0, v236
    v_cvt_pk_bf16_f32 v128, 0, v237
    v_mul_f32 v148, v236, v146
    v_mul_f32 v149, v236, v147
    v_mul_f32 v150, v146, v146
    v_mul_f32 v151, v146, v147
    v_fmac_f32 v148, v237, v251
    v_fmac_f32 v149, v237, v146
    v_fmac_f32 v150, v147, v251
    v_fmac_f32 v151, v147, v146
    v_xor_b32 v252, s46, v151
    v_mul_f32 v152, v236, v150
    v_mul_f32 v153, v236, v151
    v_mul_f32 v154, v146, v150
    v_mul_f32 v155, v146, v151
    v_mul_f32 v156, v148, v150
    v_mul_f32 v157, v148, v151
    v_mul_f32 v158, v150, v150
    v_mul_f32 v159, v150, v151
    v_fmac_f32 v152, v237, v252
    v_fmac_f32 v153, v237, v150
    v_fmac_f32 v154, v147, v252
    v_fmac_f32 v155, v147, v150
    v_fmac_f32 v156, v149, v252
    v_fmac_f32 v157, v149, v150
    v_fmac_f32 v158, v151, v252
    v_fmac_f32 v159, v151, v150
    v_xor_b32 v253, s46, v159
    v_cvt_pk_bf16_f32 v113, v146, v148
    v_cvt_pk_bf16_f32 v129, v147, v149
    v_mul_f32 v160, v236, v158
    v_mul_f32 v161, v236, v159
    v_mul_f32 v162, v146, v158
    v_mul_f32 v163, v146, v159
    v_mul_f32 v164, v148, v158
    v_mul_f32 v165, v148, v159
    v_mul_f32 v166, v150, v158
    v_mul_f32 v167, v150, v159
    v_fmac_f32 v160, v237, v253
    v_fmac_f32 v161, v237, v158
    v_fmac_f32 v162, v147, v253
    v_fmac_f32 v163, v147, v158
    v_fmac_f32 v164, v149, v253
    v_fmac_f32 v165, v149, v158
    v_fmac_f32 v166, v151, v253
    v_fmac_f32 v167, v151, v158
    v_cvt_pk_bf16_f32 v114, v150, v152
    v_cvt_pk_bf16_f32 v130, v151, v153
    v_cvt_pk_bf16_f32 v115, v154, v156
    v_cvt_pk_bf16_f32 v131, v155, v157
    v_mul_f32 v168, v152, v158
    v_mul_f32 v169, v152, v159
    v_mul_f32 v170, v154, v158
    v_mfma_f32_32x32x16_bf16 v[48:63], v[112:115], v[16:19], 0
    v_mul_f32 v171, v154, v159
    v_mul_f32 v172, v156, v158
    v_mul_f32 v173, v156, v159
    v_mul_f32 v174, v158, v158
    v_mul_f32 v175, v158, v159
    v_fmac_f32 v168, v153, v253
    v_mfma_f32_32x32x16_bf16 v[64:79], v[128:131], v[16:19], 0
    v_fmac_f32 v169, v153, v158
    v_fmac_f32 v170, v155, v253
    v_fmac_f32 v171, v155, v158
    v_fmac_f32 v172, v157, v253
    v_fmac_f32 v173, v157, v158
    v_fmac_f32 v174, v159, v253
    v_mfma_f32_32x32x16_bf16 v[80:95], v[112:115], v[32:35], 0
    v_fmac_f32 v175, v159, v158
    v_xor_b32 v144, s46, v175
    v_cvt_pk_bf16_f32 v116, v158, v160
    v_cvt_pk_bf16_f32 v132, v159, v161
    v_cvt_pk_bf16_f32 v117, v162, v164
    v_cvt_pk_bf16_f32 v133, v163, v165
    v_mfma_f32_32x32x16_bf16 v[96:111], v[128:131], v[32:35], 0
    v_mul_f32 v192, v236, v174
    v_mul_f32 v193, v236, v175
    v_mul_f32 v194, v146, v174
    v_mul_f32 v195, v146, v175
    v_mul_f32 v196, v148, v174
    v_mul_f32 v197, v148, v175
    v_mul_f32 v198, v150, v174
    v_mul_f32 v199, v150, v175
    v_fmac_f32 v192, v237, v144
    v_fmac_f32 v193, v237, v174
    v_fmac_f32 v194, v147, v144
    v_fmac_f32 v195, v147, v174
    v_fmac_f32 v196, v149, v144
    v_fmac_f32 v197, v149, v174
    v_fmac_f32 v198, v151, v144
    v_fmac_f32 v199, v151, v174
    v_cvt_pk_bf16_f32 v118, v166, v168
    v_cvt_pk_bf16_f32 v134, v167, v169
    v_cvt_pk_bf16_f32 v119, v170, v172
    v_cvt_pk_bf16_f32 v135, v171, v173
    v_mul_f32 v200, v152, v174
    v_mul_f32 v201, v152, v175
    v_mul_f32 v202, v154, v174
    v_mfma_f32_32x32x16_bf16 v[48:63], v[116:119], v[20:23], v[48:63]
    v_mul_f32 v203, v154, v175
    v_mul_f32 v204, v156, v174
    v_mul_f32 v205, v156, v175
    v_mul_f32 v206, v158, v174
    v_mul_f32 v207, v158, v175
    v_fmac_f32 v200, v153, v144
    v_mfma_f32_32x32x16_bf16 v[64:79], v[132:135], v[20:23], v[64:79]
    v_fmac_f32 v201, v153, v174
    v_fmac_f32 v202, v155, v144
    v_fmac_f32 v203, v155, v174
    v_fmac_f32 v204, v157, v144
    v_fmac_f32 v205, v157, v174
    v_fmac_f32 v206, v159, v144
    v_mfma_f32_32x32x16_bf16 v[80:95], v[116:119], v[36:39], v[80:95]
    v_fmac_f32 v207, v159, v174
    v_cvt_pk_bf16_f32 v120, v174, v192
    v_cvt_pk_bf16_f32 v136, v175, v193
    v_cvt_pk_bf16_f32 v121, v194, v196
    v_cvt_pk_bf16_f32 v137, v195, v197
    v_mul_f32 v208, v160, v174
    v_mfma_f32_32x32x16_bf16 v[96:111], v[132:135], v[36:39], v[96:111]
    v_mul_f32 v209, v160, v175
    v_mul_f32 v210, v162, v174
    v_mul_f32 v211, v162, v175
    v_mul_f32 v212, v164, v174
    v_mul_f32 v213, v164, v175
    v_mul_f32 v214, v166, v174
    v_mul_f32 v215, v166, v175
    v_fmac_f32 v208, v161, v144
    v_fmac_f32 v209, v161, v174
    v_fmac_f32 v210, v163, v144
    v_fmac_f32 v211, v163, v174
    v_fmac_f32 v212, v165, v144
    v_fmac_f32 v213, v165, v174
    v_fmac_f32 v214, v167, v144
    v_fmac_f32 v215, v167, v174
    v_cvt_pk_bf16_f32 v122, v198, v200
    v_cvt_pk_bf16_f32 v138, v199, v201
    v_cvt_pk_bf16_f32 v123, v202, v204
    v_cvt_pk_bf16_f32 v139, v203, v205
    v_mul_f32 v216, v168, v174
    v_mul_f32 v217, v168, v175
    v_mul_f32 v218, v170, v174
    v_mfma_f32_32x32x16_bf16 v[48:63], v[120:123], v[24:27], v[48:63]
    v_mul_f32 v219, v170, v175
    v_mul_f32 v220, v172, v174
    v_mul_f32 v221, v172, v175
    v_fmac_f32 v216, v169, v144
    v_fmac_f32 v217, v169, v174
    v_fmac_f32 v218, v171, v144
    v_mfma_f32_32x32x16_bf16 v[64:79], v[136:139], v[24:27], v[64:79]
    v_fmac_f32 v219, v171, v174
    v_fmac_f32 v220, v173, v144
    v_fmac_f32 v221, v173, v174
    v_cvt_pk_bf16_f32 v124, v206, v208
    v_cvt_pk_bf16_f32 v140, v207, v209
    v_cvt_pk_bf16_f32 v125, v210, v212
    v_mfma_f32_32x32x16_bf16 v[80:95], v[120:123], v[40:43], v[80:95]
    v_cvt_pk_bf16_f32 v141, v211, v213
    v_cvt_pk_bf16_f32 v126, v214, v216
    v_cvt_pk_bf16_f32 v142, v215, v217
    v_cvt_pk_bf16_f32 v127, v218, v220
    v_cvt_pk_bf16_f32 v143, v219, v221
    s_setprio 3
    global_load_dword v250, v255, s[92:93] sc1
NI11:
    s_setprio 1
    v_and_b32 v10, 0xffff0000, v246
    v_mfma_f32_32x32x16_bf16 v[96:111], v[136:139], v[40:43], v[96:111]
    v_and_b32 v11, 0xffff0000, v247
    v_and_b32 v12, 0xffff0000, v248
    v_and_b32 v13, 0xffff0000, v249
    v_xor_b32 v251, s46, v239
    v_mul_f32 v10, v10, v14
    v_mul_f32 v11, v11, v14
    v_mfma_f32_32x32x16_bf16 v[48:63], v[124:127], v[28:31], v[48:63]
    v_mul_f32 v222, v12, v10
    v_mul_f32 v223, v12, v11
    v_fma_f32 v222, -v13, v11, v222
    v_fmac_f32 v223, v13, v10
    v_mul_f32 v224, v222, v236
    v_mul_f32 v225, v222, v237
    v_mfma_f32_32x32x16_bf16 v[64:79], v[140:143], v[28:31], v[64:79]
    v_mul_f32 v226, v222, v238
    v_mul_f32 v227, v222, v239
    v_mul_f32 v228, v222, v242
    v_mul_f32 v229, v222, v243
    v_fmac_f32 v224, v223, v240
    v_fmac_f32 v225, v223, v236
    v_mfma_f32_32x32x16_bf16 v[80:95], v[124:127], v[44:47], v[80:95]
    v_fmac_f32 v226, v223, v251
    v_fmac_f32 v227, v223, v238
    v_fmac_f32 v228, v223, v15
    v_fmac_f32 v229, v223, v242
    v_mul_f32 v230, v224, v242
    v_mul_f32 v231, v224, v243
    v_mfma_f32_32x32x16_bf16 v[96:111], v[140:143], v[44:47], v[96:111]
    v_mul_f32 v232, v226, v238
    v_mul_f32 v233, v226, v239
    v_mul_f32 v234, v228, v242
    v_mul_f32 v235, v228, v243
    v_fmac_f32 v230, v225, v15
    v_fmac_f32 v231, v225, v242
    v_fmac_f32 v232, v227, v251
    v_fmac_f32 v233, v227, v238
    v_fmac_f32 v234, v229, v15
    v_fmac_f32 v235, v229, v242
    v_mul_f32 v192, v230, v242
    v_mul_f32 v193, v230, v243
    v_mul_f32 v194, v232, v238
    v_mul_f32 v195, v232, v239
    v_mul_f32 v196, v234, v242
    v_mul_f32 v197, v234, v243
    v_mul_f32 v198, v232, v242
    v_mul_f32 v199, v232, v243
    v_fmac_f32 v192, v231, v15
    v_fmac_f32 v193, v231, v242
    v_fmac_f32 v194, v233, v251
    v_fmac_f32 v195, v233, v238
    v_fmac_f32 v196, v235, v15
    v_fmac_f32 v197, v235, v242
    v_fmac_f32 v198, v233, v15
    v_fmac_f32 v199, v233, v242
    v_perm_b32 v112, v64, v48, s47
    v_perm_b32 v113, v65, v49, s47
    v_perm_b32 v114, v66, v50, s47
    v_perm_b32 v115, v67, v51, s47
    v_perm_b32 v116, v68, v52, s47
    v_perm_b32 v117, v69, v53, s47
    v_perm_b32 v118, v70, v54, s47
    v_perm_b32 v119, v71, v55, s47
    v_perm_b32 v120, v72, v56, s47
    v_perm_b32 v121, v73, v57, s47
    v_perm_b32 v122, v74, v58, s47
    v_perm_b32 v123, v75, v59, s47
    v_perm_b32 v124, v76, v60, s47
    v_perm_b32 v125, v77, v61, s47
    v_perm_b32 v126, v78, v62, s47
    v_perm_b32 v127, v79, v63, s47
    v_perm_b32 v128, v96, v80, s47
    v_perm_b32 v129, v97, v81, s47
    v_perm_b32 v130, v98, v82, s47
    v_perm_b32 v131, v99, v83, s47
    v_perm_b32 v132, v100, v84, s47
    v_perm_b32 v133, v101, v85, s47
    v_perm_b32 v134, v102, v86, s47
    v_perm_b32 v135, v103, v87, s47
    v_perm_b32 v136, v104, v88, s47
    v_perm_b32 v137, v105, v89, s47
    v_perm_b32 v138, v106, v90, s47
    v_perm_b32 v139, v107, v91, s47
    v_perm_b32 v140, v108, v92, s47
    v_perm_b32 v141, v109, v93, s47
    v_perm_b32 v142, v110, v94, s47
    v_perm_b32 v143, v111, v95, s47
    v_cvt_pk_bf16_f32 v144, v222, v226
    v_cvt_pk_bf16_f32 v160, -v223, -v227
    v_cvt_pk_bf16_f32 v146, v228, v228
    v_cvt_pk_bf16_f32 v162, -v229, -v229
    v_cvt_pk_bf16_f32 v152, v224, v234
    v_cvt_pk_bf16_f32 v168, -v225, -v235
    v_mul_f32 v200, v192, v242
    v_mul_f32 v201, v192, v243
    v_mul_f32 v202, v194, v238
    v_mul_f32 v203, v194, v239
    v_mul_f32 v204, v196, v242
    v_mul_f32 v205, v196, v243
    v_fmac_f32 v200, v193, v15
    v_fmac_f32 v201, v193, v242
    v_fmac_f32 v202, v195, v251
    v_fmac_f32 v203, v195, v238
    v_fmac_f32 v204, v197, v15
    v_fmac_f32 v205, v197, v242
    v_cvt_pk_bf16_f32 v145, v232, v194
    v_cvt_pk_bf16_f32 v161, -v233, -v195
    v_cvt_pk_bf16_f32 v154, v230, v196
    v_cvt_pk_bf16_f32 v170, -v231, -v197
    v_mul_f32 v206, v200, v242
    v_mul_f32 v207, v200, v243
    v_mul_f32 v208, v202, v242
    v_mul_f32 v209, v202, v243
    v_mul_f32 v210, v202, v238
    v_mul_f32 v211, v202, v239
    v_mul_f32 v212, v204, v242
    v_mul_f32 v213, v204, v243
    v_fmac_f32 v206, v201, v15
    v_fmac_f32 v207, v201, v242
    v_fmac_f32 v208, v203, v15
    v_fmac_f32 v209, v203, v242
    v_fmac_f32 v210, v203, v251
    v_fmac_f32 v211, v203, v238
    v_fmac_f32 v212, v205, v15
    v_fmac_f32 v213, v205, v242
    v_mul_f32 v214, v206, v242
    v_mul_f32 v215, v206, v243
    v_mul_f32 v216, v210, v238
    v_mul_f32 v217, v210, v239
    v_mul_f32 v218, v208, v242
    v_mul_f32 v219, v208, v243
    v_mul_f32 v220, v212, v242
    v_mul_f32 v221, v212, v243
    v_fmac_f32 v214, v207, v15
    v_fmac_f32 v215, v207, v242
    v_fmac_f32 v216, v211, v251
    v_fmac_f32 v217, v211, v238
    v_fmac_f32 v218, v209, v15
    v_fmac_f32 v219, v209, v242
    v_fmac_f32 v220, v213, v15
    v_fmac_f32 v221, v213, v242
    v_cvt_pk_bf16_f32 v147, v198, v208
    v_cvt_pk_bf16_f32 v163, -v199, -v209
    v_cvt_pk_bf16_f32 v148, v202, v210
    v_cvt_pk_bf16_f32 v164, -v203, -v211
    v_cvt_pk_bf16_f32 v150, v208, v208
    v_mfma_f32_32x32x16_bf16 v[48:63], v[144:147], v[16:19], 0
    v_cvt_pk_bf16_f32 v166, -v209, -v209
    v_cvt_pk_bf16_f32 v156, v204, v206
    v_cvt_pk_bf16_f32 v172, -v205, -v207
    v_mul_f32 v222, v214, v242
    v_mul_f32 v223, v214, v243
    v_mul_f32 v226, v216, v238
    v_mfma_f32_32x32x16_bf16 v[64:79], v[160:163], v[16:19], 0
    v_mul_f32 v227, v216, v239
    v_mul_f32 v228, v216, v242
    v_mul_f32 v229, v216, v243
    v_mul_f32 v224, v218, v242
    v_mul_f32 v225, v218, v243
    v_fmac_f32 v222, v215, v15
    v_mfma_f32_32x32x16_bf16 v[80:95], v[144:147], v[32:35], 0
    v_fmac_f32 v223, v215, v242
    v_fmac_f32 v226, v217, v251
    v_fmac_f32 v227, v217, v238
    v_fmac_f32 v228, v217, v15
    v_fmac_f32 v229, v217, v242
    v_fmac_f32 v224, v219, v15
    v_mfma_f32_32x32x16_bf16 v[96:111], v[160:163], v[32:35], 0
    v_fmac_f32 v225, v219, v242
    v_cvt_pk_bf16_f32 v153, v218, v192
    v_cvt_pk_bf16_f32 v169, -v219, -v193
    v_cvt_pk_bf16_f32 v158, v212, v214
    v_cvt_pk_bf16_f32 v174, -v213, -v215
    v_mul_f32 v234, v220, v242
    v_mul_f32 v235, v220, v243
    v_mul_f32 v232, v222, v242
    v_mul_f32 v233, v222, v243
    v_fmac_f32 v234, v221, v15
    v_fmac_f32 v235, v221, v242
    v_fmac_f32 v232, v223, v15
    v_fmac_f32 v233, v223, v242
    v_cvt_pk_bf16_f32 v149, v216, v226
    v_cvt_pk_bf16_f32 v165, -v217, -v227
    v_cvt_pk_bf16_f32 v151, v228, v230
    v_cvt_pk_bf16_f32 v167, -v229, -v231
    v_cvt_pk_bf16_f32 v155, v224, v200
    v_cvt_pk_bf16_f32 v171, -v225, -v201
    v_cvt_pk_bf16_f32 v157, v220, v222
    v_mfma_f32_32x32x16_bf16 v[48:63], v[148:151], v[20:23], v[48:63]
    v_cvt_pk_bf16_f32 v173, -v221, -v223
    v_cvt_pk_bf16_f32 v159, v234, v232
    v_cvt_pk_bf16_f32 v175, -v235, -v233
    v_mfma_f32_32x32x16_bf16 v[64:79], v[164:167], v[20:23], v[64:79]
    v_mfma_f32_32x32x16_bf16 v[80:95], v[148:151], v[36:39], v[80:95]
    v_mfma_f32_32x32x16_bf16 v[96:111], v[164:167], v[36:39], v[96:111]
    v_mfma_f32_32x32x16_bf16 v[48:63], v[152:155], v[24:27], v[48:63]
    v_mfma_f32_32x32x16_bf16 v[64:79], v[168:171], v[24:27], v[64:79]
    v_mfma_f32_32x32x16_bf16 v[80:95], v[152:155], v[40:43], v[80:95]
    v_mfma_f32_32x32x16_bf16 v[96:111], v[168:171], v[40:43], v[96:111]
    v_mfma_f32_32x32x16_bf16 v[48:63], v[156:159], v[28:31], v[48:63]
    v_mfma_f32_32x32x16_bf16 v[64:79], v[172:175], v[28:31], v[64:79]
    v_mfma_f32_32x32x16_bf16 v[80:95], v[156:159], v[44:47], v[80:95]
    v_mfma_f32_32x32x16_bf16 v[96:111], v[172:175], v[44:47], v[96:111]
    v_and_b32 v4, 31, v1
    v_mul_u32_u24 v4, 272, v4
    v_lshrrev_b32 v5, 5, v1
    v_lshl_add_u32 v4, v5, 4, v4
    v_add_u32 v4, s29, v4
    v_mov_b32 v5, v4
    s_add_u32 s33, s29, 1088
    v_writelane_b32 v5, s33, 5
    s_add_u32 s33, s33, 16
    v_writelane_b32 v5, s33, 37
    s_add_u32 s33, s29, 1904
    v_writelane_b32 v5, s33, 12
    s_add_u32 s33, s33, 16
    v_writelane_b32 v5, s33, 44
    s_add_u32 s33, s29, 1904
    v_writelane_b32 v5, s33, 13
    s_add_u32 s33, s33, 16
    v_writelane_b32 v5, s33, 45
    s_add_u32 s33, s29, 4080
    v_writelane_b32 v5, s33, 20
    s_add_u32 s33, s33, 16
    v_writelane_b32 v5, s33, 52
    ds_read_b128 v[16:19], v5 offset:0
    ds_read_b128 v[20:23], v4 offset:8704
    ds_read_b128 v[24:27], v5 offset:32
    ds_read_b128 v[28:31], v4 offset:8736
    ds_read_b128 v[32:35], v5 offset:64
    ds_read_b128 v[36:39], v4 offset:8768
    ds_read_b128 v[40:43], v5 offset:96
    ds_read_b128 v[44:47], v4 offset:8800
    ds_read_b128 v[200:203], v5 offset:128
    ds_read_b128 v[204:207], v4 offset:8832
    ds_read_b128 v[208:211], v5 offset:160
    ds_read_b128 v[212:215], v4 offset:8864
    ds_read_b128 v[216:219], v5 offset:192
    ds_read_b128 v[220:223], v4 offset:8896
    ds_read_b128 v[224:227], v5 offset:224
    ds_read_b128 v[228:231], v4 offset:8928
    s_setprio 3
    s_waitcnt vmcnt(0)
    s_mov_b32 s62, 40000
NT12:
    v_readfirstlane_b32 s60, v250
    s_nop 1
    s_cmp_ge_u32 s60, 8
    s_cbranch_scc1 ND12
    s_sub_u32 s62, s62, 1
    s_cbranch_scc1 ND12
    s_sleep 8
    global_load_dword v250, v255, s[92:93] sc1
    s_waitcnt vmcnt(0)
    s_branch NT12
ND12:
    v_mov_b32 v250, 0
    s_mov_b64 exec, 1
    buffer_atomic_add v250, v255, s[20:23], s42 offen sc0 sc1
    s_mov_b64 exec, -1
    s_setprio 1
    v_perm_b32 v144, v64, v48, s47
    v_perm_b32 v145, v65, v49, s47
    v_perm_b32 v146, v66, v50, s47
    v_perm_b32 v147, v67, v51, s47
    v_perm_b32 v148, v68, v52, s47
    v_perm_b32 v149, v69, v53, s47
    v_perm_b32 v150, v70, v54, s47
    v_perm_b32 v151, v71, v55, s47
    v_perm_b32 v152, v72, v56, s47
    v_perm_b32 v153, v73, v57, s47
    v_perm_b32 v154, v74, v58, s47
    v_perm_b32 v155, v75, v59, s47
    v_perm_b32 v156, v76, v60, s47
    v_perm_b32 v157, v77, v61, s47
    v_perm_b32 v158, v78, v62, s47
    v_perm_b32 v159, v79, v63, s47
    v_perm_b32 v160, v96, v80, s47
    v_perm_b32 v161, v97, v81, s47
    v_perm_b32 v162, v98, v82, s47
    v_mfma_f32_32x32x16_bf16 v[176:191], v[144:147], v[112:115], 0
    v_perm_b32 v163, v99, v83, s47
    v_perm_b32 v164, v100, v84, s47
    v_perm_b32 v165, v101, v85, s47
    v_perm_b32 v166, v102, v86, s47
    v_mfma_f32_32x32x16_bf16 v[176:191], v[148:151], v[116:119], v[176:191]
    v_perm_b32 v167, v103, v87, s47
    v_perm_b32 v168, v104, v88, s47
    v_perm_b32 v169, v105, v89, s47
    v_perm_b32 v170, v106, v90, s47
    v_mfma_f32_32x32x16_bf16 v[176:191], v[152:155], v[120:123], v[176:191]
    v_perm_b32 v171, v107, v91, s47
    v_perm_b32 v172, v108, v92, s47
    v_perm_b32 v173, v109, v93, s47
    v_perm_b32 v174, v110, v94, s47
    v_mfma_f32_32x32x16_bf16 v[176:191], v[156:159], v[124:127], v[176:191]
    v_perm_b32 v175, v111, v95, s47
    s_waitcnt lgkmcnt(0)
    v_mfma_f32_32x32x16_bf16 v[176:191], v[16:19], v[20:23], v[176:191]
    v_mfma_f32_32x32x16_bf16 v[176:191], v[24:27], v[28:31], v[176:191]
    v_mfma_f32_32x32x16_bf16 v[176:191], v[32:35], v[36:39], v[176:191]
    v_mfma_f32_32x32x16_bf16 v[176:191], v[40:43], v[44:47], v[176:191]
    v_mfma_f32_32x32x16_bf16 v[176:191], v[200:203], v[204:207], v[176:191]
    v_mfma_f32_32x32x16_bf16 v[176:191], v[208:211], v[212:215], v[176:191]
    v_mfma_f32_32x32x16_bf16 v[176:191], v[216:219], v[220:223], v[176:191]
    v_mfma_f32_32x32x16_bf16 v[176:191], v[224:227], v[228:231], v[176:191]
    v_mfma_f32_32x32x16_bf16 v[176:191], v[160:163], v[128:131], v[176:191]
    v_mfma_f32_32x32x16_bf16 v[176:191], v[164:167], v[132:135], v[176:191]
    v_mfma_f32_32x32x16_bf16 v[176:191], v[168:171], v[136:139], v[176:191]
    v_mfma_f32_32x32x16_bf16 v[176:191], v[172:175], v[140:143], v[176:191]
    s_setprio 3
    v_add_u32 v242, s29, v2
    s_xor_b32 s33, s24, 1
    s_mul_i32 s33, s33, 17408
    v_add_u32 v243, s33, v2
    s_and_b32 s33, s24, 2
    s_mul_i32 s48, s33, 17408
    s_add_u32 s48, s48, 4096
    s_mul_i32 s33, s27, 4160
    s_add_u32 s49, s33, s48
    v_sub_u32 v6, 63, v1
    v_lshlrev_b32 v6, 4, v6
    v_add_u32 v6, s49, v6
    v_and_b32 v7, 1, v1
    v_cmp_eq_u32 vcc, 1, v7
    ds_write_b128 v242, v[176:179] offset:0
    ds_write_b128 v242, v[180:183] offset:1024
    ds_write_b128 v242, v[184:187] offset:2048
    ds_write_b128 v242, v[188:191] offset:3072
    v_lshrrev_b32 v4, 4, v1
    v_and_b32 v5, 15, v1
    v_add_u32 v7, 1, v5
    v_lshrrev_b32 v7, 1, v7
    v_lshlrev_b32 v8, 2, v4
    v_sub_u32 v8, v8, v7
    v_and_b32 v7, 1, v5
    v_mul_u32_u24 v7, 1040, v7
    v_sub_u32 v8, v8, v7
    v_add_u32 v8, 1880, v8
    v_lshlrev_b32 v8, 2, v8
    s_lshl_b32 s33, s27, 8
    s_sub_u32 s33, s48, s33
    v_add_u32 v8, s33, v8
    v_subrev_u32 v9, 1024, v8
    v_subrev_u32 v10, 2048, v8
    v_subrev_u32 v11, 3072, v8
    s_waitcnt lgkmcnt(0)
    s_barrier
    ds_read_b128 v[48:51], v243 offset:0
    ds_read_b128 v[52:55], v243 offset:1024
    ds_read_b128 v[56:59], v243 offset:2048
    ds_read_b128 v[60:63], v243 offset:3072
    s_cmp_eq_u32 s45, 64
    s_cbranch_scc1 TU2c
    s_setprio 3
    s_waitcnt vmcnt(0)
    v_readfirstlane_b32 s45, v250
    s_nop 1
    s_cmp_lg_u32 s45, 64
    s_cbranch_scc1 TU0c
    buffer_load_dwordx4 v[192:195], v3, s[20:23], s43 offen sc1
    buffer_load_dwordx4 v[196:199], v3, s[20:23], s44 offen sc1
    s_branch TU1c
TU0c:
    v_mov_b32 v250, 0
    s_mov_b64 exec, 1
    buffer_atomic_add v250, v255, s[20:23], s42 offen sc0 sc1
    s_mov_b64 exec, -1
TU1c:
    s_setprio 3
TU2c:
    s_lshr_b32 s33, s24, 1
    s_mul_i32 s36, s33, 4608
    s_add_u32 s36, s36, 70144
    v_lshlrev_b32 v12, 5, v5
    v_lshl_add_u32 v13, v4, 3, v12
    v_lshl_add_u32 v12, v4, 4, v12
    s_lshl_b32 s33, s27, 8
    s_sub_u32 s33, s36, s33
    s_sub_u32 s33, s33, 224
    v_add_u32 v12, s33, v12
    s_lshl_b32 s33, s27, 11
    s_add_u32 s33, s33, s36
    v_add_u32 v13, s33, v13
    s_lshl_b32 s40, s26, 1
    s_add_u32 s40, s40, s27
    s_lshl_b32 s41, s40, 11
    s_add_u32 s41, s41, 6881280
    s_lshr_b32 s40, s26, 5
    s_lshl_b32 s40, s40, 7
    s_add_u32 s40, s40, 6811648
    s_waitcnt lgkmcnt(0)
    v_add_f32 v176, v176, v48
    v_add_f32 v177, v177, v49
    v_add_f32 v178, v178, v50
    v_add_f32 v179, v179, v51
    v_add_f32 v180, v180, v52
    v_add_f32 v181, v181, v53
    v_add_f32 v182, v182, v54
    v_add_f32 v183, v183, v55
    v_add_f32 v184, v184, v56
    v_add_f32 v185, v185, v57
    v_add_f32 v186, v186, v58
    v_add_f32 v187, v187, v59
    v_add_f32 v188, v188, v60
    v_add_f32 v189, v189, v61
    v_add_f32 v190, v190, v62
    v_add_f32 v191, v191, v63
    v_cndmask_b32 v112, v188, v189, vcc
    v_cndmask_b32 v113, v190, v191, vcc
    v_mov_b32 v80, 0
    v_mov_b32 v81, 0
    v_mov_b32 v82, 0
    v_mov_b32 v83, 0
    s_cmp_eq_u32 s27, 1
    s_cbranch_scc1 B_ODD
    v_cvt_pk_bf16_f32 v64, v183, v182
    v_cvt_pk_bf16_f32 v65, v181, v180
    v_cvt_pk_bf16_f32 v66, v179, v178
    v_cvt_pk_bf16_f32 v67, v177, v176
    v_cvt_pk_bf16_f32 v68, v187, v187
    v_cvt_pk_bf16_f32 v69, v186, v186
    v_cvt_pk_bf16_f32 v70, v186, v185
    v_cvt_pk_bf16_f32 v71, v185, v185
    v_cvt_pk_bf16_f32 v72, v189, v189
    v_cvt_pk_bf16_f32 v73, v189, v112
    v_cvt_pk_bf16_f32 v74, v188, v188
    v_cvt_pk_bf16_f32 v75, v188, v188
    v_cvt_pk_bf16_f32 v76, v191, v191
    v_cvt_pk_bf16_f32 v77, v191, v113
    v_cvt_pk_bf16_f32 v78, v190, v190
    v_cvt_pk_bf16_f32 v79, v190, v190
    s_branch B_IMG
B_ODD:
    v_cvt_pk_bf16_f32 v64, v184, v183
    v_cvt_pk_bf16_f32 v65, v182, v181
    v_cvt_pk_bf16_f32 v66, v180, v179
    v_cvt_pk_bf16_f32 v67, v178, v177
    v_cvt_pk_bf16_f32 v68, v187, v187
    v_cvt_pk_bf16_f32 v69, v187, v186
    v_cvt_pk_bf16_f32 v70, v186, v186
    v_cvt_pk_bf16_f32 v71, v185, v185
    v_cvt_pk_bf16_f32 v72, v189, v189
    v_cvt_pk_bf16_f32 v73, v189, v189
    v_cvt_pk_bf16_f32 v74, v112, v188
    v_cvt_pk_bf16_f32 v75, v188, v188
    v_cvt_pk_bf16_f32 v76, v191, v191
    v_cvt_pk_bf16_f32 v77, v191, v191
    v_cvt_pk_bf16_f32 v78, v113, v190
    v_cvt_pk_bf16_f32 v79, v190, v190
    s_mov_b64 exec, 1
    v_cvt_pk_bf16_f32 v80, v176, v255
    s_mov_b64 exec, -1
B_IMG:
    ds_write_b128 v6, v[64:67] offset:3072
    ds_write_b128 v6, v[68:71] offset:2048
    ds_write_b128 v6, v[72:75] offset:1024
    ds_write_b128 v6, v[76:79] offset:0
    v_add_u32 v7, s49, v2
    s_mov_b64 exec, 3
    ds_write_b128 v7, v[80:83] offset:4096
    s_mov_b64 exec, -1
    s_cmp_eq_u32 s45, 64
    s_cbranch_scc1 B_UOK
    s_waitcnt vmcnt(0)
    s_mov_b32 s62, 40000
FC13:
    v_readfirstlane_b32 s4, v250
    s_nop 1
    s_cmp_eq_u32 s4, 64
    s_cbranch_scc1 FD13
    s_sub_u32 s62, s62, 1
    s_cbranch_scc1 FD13
    s_sleep 4
    v_mov_b32 v250, 0
    s_mov_b64 exec, 1
    buffer_atomic_add v250, v255, s[20:23], s42 offen sc0 sc1
    s_mov_b64 exec, -1
    s_waitcnt vmcnt(0)
    s_branch FC13
FD13:
    buffer_load_dwordx4 v[192:195], v3, s[20:23], s43 offen sc1
    buffer_load_dwordx4 v[196:199], v3, s[20:23], s44 offen sc1
B_UOK:
    s_waitcnt vmcnt(0)
    ds_write_b128 v241, v[192:195] offset:0
    ds_write_b128 v241, v[196:199] offset:512
    s_waitcnt lgkmcnt(0)
    s_barrier
    s_setprio 0
    ds_read2_b32 v[16:17], v8 offset0:176 offset1:177
    ds_read2_b32 v[18:19], v8 offset0:178 offset1:179
    ds_read_b128 v[48:51], v12 offset:192
    ds_read2_b32 v[20:21], v8 offset0:48 offset1:49
    ds_read2_b32 v[22:23], v8 offset0:50 offset1:51
    ds_read_b128 v[52:55], v12 offset:704
    ds_read2_b32 v[24:25], v9 offset0:176 offset1:177
    ds_read2_b32 v[26:27], v9 offset0:178 offset1:179
    ds_read_b128 v[56:59], v12 offset:1216
    ds_read2_b32 v[28:29], v9 offset0:48 offset1:49
    ds_read2_b32 v[30:31], v9 offset0:50 offset1:51
    ds_read_b128 v[60:63], v12 offset:1728
    ds_read2_b32 v[32:33], v10 offset0:176 offset1:177
    ds_read2_b32 v[34:35], v10 offset0:178 offset1:179
    ds_read_b128 v[64:67], v12 offset:2240
    ds_read2_b32 v[36:37], v10 offset0:48 offset1:49
    ds_read2_b32 v[38:39], v10 offset0:50 offset1:51
    ds_read_b128 v[68:71], v12 offset:2752
    ds_read2_b32 v[40:41], v11 offset0:176 offset1:177
    ds_read2_b32 v[42:43], v11 offset0:178 offset1:179
    ds_read_b128 v[72:75], v12 offset:3264
    ds_read2_b32 v[44:45], v11 offset0:48 offset1:49
    ds_read2_b32 v[46:47], v11 offset0:50 offset1:51
    ds_read_b128 v[76:79], v12 offset:3776
    s_waitcnt lgkmcnt(15)
    v_mfma_f32_16x16x32_bf16 v[144:147], v[16:19], v[48:51], 0
    s_waitcnt lgkmcnt(15)
    v_mfma_f32_16x16x32_bf16 v[148:151], v[16:19], v[52:55], 0
    v_mfma_f32_16x16x32_bf16 v[148:151], v[20:23], v[48:51], v[148:151]
    v_mfma_f32_16x16x32_bf16 v[152:155], v[20:23], v[52:55], 0
    s_waitcnt lgkmcnt(15)
    v_mfma_f32_16x16x32_bf16 v[152:155], v[16:19], v[56:59], v[152:155]
    v_mfma_f32_16x16x32_bf16 v[152:155], v[24:27], v[48:51], v[152:155]
    v_mfma_f32_16x16x32_bf16 v[156:159], v[20:23], v[56:59], 0
    v_mfma_f32_16x16x32_bf16 v[156:159], v[24:27], v[52:55], v[156:159]
    v_mfma_f32_16x16x32_bf16 v[160:163], v[24:27], v[56:59], 0
    ds_read2_b32 v[80:81], v8 offset0:160 offset1:161
    s_waitcnt lgkmcnt(13)
    v_mfma_f32_16x16x32_bf16 v[156:159], v[16:19], v[60:63], v[156:159]
    ds_read2_b32 v[82:83], v8 offset0:162 offset1:163
    v_mfma_f32_16x16x32_bf16 v[156:159], v[28:31], v[48:51], v[156:159]
    ds_read_b128 v[112:115], v12 offset:128
    v_mfma_f32_16x16x32_bf16 v[160:163], v[20:23], v[60:63], v[160:163]
    ds_read2_b32 v[84:85], v8 offset0:32 offset1:33
    v_mfma_f32_16x16x32_bf16 v[160:163], v[28:31], v[52:55], v[160:163]
    ds_read2_b32 v[86:87], v8 offset0:34 offset1:35
    v_mfma_f32_16x16x32_bf16 v[164:167], v[24:27], v[60:63], 0
    ds_read_b128 v[116:119], v12 offset:640
    v_mfma_f32_16x16x32_bf16 v[164:167], v[28:31], v[56:59], v[164:167]
    ds_read2_b32 v[88:89], v9 offset0:160 offset1:161
    v_mfma_f32_16x16x32_bf16 v[168:171], v[28:31], v[60:63], 0
    ds_read2_b32 v[90:91], v9 offset0:162 offset1:163
    s_waitcnt lgkmcnt(15)
    v_mfma_f32_16x16x32_bf16 v[160:163], v[16:19], v[64:67], v[160:163]
    ds_read_b128 v[120:123], v12 offset:1152
    v_mfma_f32_16x16x32_bf16 v[160:163], v[32:35], v[48:51], v[160:163]
    ds_read2_b32 v[92:93], v9 offset0:32 offset1:33
    v_mfma_f32_16x16x32_bf16 v[164:167], v[20:23], v[64:67], v[164:167]
    ds_read2_b32 v[94:95], v9 offset0:34 offset1:35
    v_mfma_f32_16x16x32_bf16 v[164:167], v[32:35], v[52:55], v[164:167]
    ds_read_b128 v[124:127], v12 offset:1664
    v_mfma_f32_16x16x32_bf16 v[168:171], v[24:27], v[64:67], v[168:171]
    ds_read2_b32 v[96:97], v10 offset0:160 offset1:161
    v_mfma_f32_16x16x32_bf16 v[168:171], v[32:35], v[56:59], v[168:171]
    ds_read2_b32 v[98:99], v10 offset0:162 offset1:163
    v_mfma_f32_16x16x32_bf16 v[172:175], v[28:31], v[64:67], 0
    ds_read_b128 v[128:131], v12 offset:2176
    v_mfma_f32_16x16x32_bf16 v[172:175], v[32:35], v[60:63], v[172:175]
    ds_read2_b32 v[100:101], v10 offset0:32 offset1:33
    s_waitcnt lgkmcnt(15)
    v_mfma_f32_16x16x32_bf16 v[164:167], v[16:19], v[68:71], v[164:167]
    ds_read2_b32 v[102:103], v10 offset0:34 offset1:35
    v_mfma_f32_16x16x32_bf16 v[164:167], v[36:39], v[48:51], v[164:167]
    ds_read_b128 v[132:135], v12 offset:2688
    v_mfma_f32_16x16x32_bf16 v[168:171], v[20:23], v[68:71], v[168:171]
    ds_read2_b32 v[104:105], v11 offset0:160 offset1:161
    v_mfma_f32_16x16x32_bf16 v[168:171], v[36:39], v[52:55], v[168:171]
    ds_read2_b32 v[106:107], v11 offset0:162 offset1:163
    v_mfma_f32_16x16x32_bf16 v[172:175], v[24:27], v[68:71], v[172:175]
    ds_read_b128 v[136:139], v12 offset:3200
    v_mfma_f32_16x16x32_bf16 v[172:175], v[36:39], v[56:59], v[172:175]
    ds_read2_b32 v[108:109], v11 offset0:32 offset1:33
    s_waitcnt lgkmcnt(15)
    v_mfma_f32_16x16x32_bf16 v[168:171], v[16:19], v[72:75], v[168:171]
    ds_read2_b32 v[110:111], v11 offset0:34 offset1:35
    v_mfma_f32_16x16x32_bf16 v[168:171], v[40:43], v[48:51], v[168:171]
    ds_read_b128 v[140:143], v12 offset:3712
    v_mfma_f32_16x16x32_bf16 v[172:175], v[20:23], v[72:75], v[172:175]
    v_mfma_f32_16x16x32_bf16 v[172:175], v[40:43], v[52:55], v[172:175]
    s_waitcnt lgkmcnt(15)
    v_mfma_f32_16x16x32_bf16 v[172:175], v[16:19], v[76:79], v[172:175]
    v_mfma_f32_16x16x32_bf16 v[172:175], v[44:47], v[48:51], v[172:175]
    s_waitcnt lgkmcnt(15)
    v_mfma_f32_16x16x32_bf16 v[144:147], v[80:83], v[112:115], v[144:147]
    s_waitcnt lgkmcnt(15)
    v_mfma_f32_16x16x32_bf16 v[148:151], v[80:83], v[116:119], v[148:151]
    v_mfma_f32_16x16x32_bf16 v[148:151], v[84:87], v[112:115], v[148:151]
    v_mfma_f32_16x16x32_bf16 v[152:155], v[84:87], v[116:119], v[152:155]
    s_waitcnt lgkmcnt(15)
    v_mfma_f32_16x16x32_bf16 v[152:155], v[80:83], v[120:123], v[152:155]
    v_mfma_f32_16x16x32_bf16 v[152:155], v[88:91], v[112:115], v[152:155]
    v_mfma_f32_16x16x32_bf16 v[156:159], v[84:87], v[120:123], v[156:159]
    v_mfma_f32_16x16x32_bf16 v[156:159], v[88:91], v[116:119], v[156:159]
    v_mfma_f32_16x16x32_bf16 v[160:163], v[88:91], v[120:123], v[160:163]
    ds_read2_b32 v[16:17], v8 offset0:144 offset1:145
    s_waitcnt lgkmcnt(13)
    v_mfma_f32_16x16x32_bf16 v[156:159], v[80:83], v[124:127], v[156:159]
    ds_read2_b32 v[18:19], v8 offset0:146 offset1:147
    v_mfma_f32_16x16x32_bf16 v[156:159], v[92:95], v[112:115], v[156:159]
    ds_read_b128 v[48:51], v12 offset:64
    v_mfma_f32_16x16x32_bf16 v[160:163], v[84:87], v[124:127], v[160:163]
    ds_read2_b32 v[20:21], v8 offset0:16 offset1:17
    v_mfma_f32_16x16x32_bf16 v[160:163], v[92:95], v[116:119], v[160:163]
    ds_read2_b32 v[22:23], v8 offset0:18 offset1:19
    v_mfma_f32_16x16x32_bf16 v[164:167], v[88:91], v[124:127], v[164:167]
    ds_read_b128 v[52:55], v12 offset:576
    v_mfma_f32_16x16x32_bf16 v[164:167], v[92:95], v[120:123], v[164:167]
    ds_read2_b32 v[24:25], v9 offset0:144 offset1:145
    v_mfma_f32_16x16x32_bf16 v[168:171], v[92:95], v[124:127], v[168:171]
    ds_read2_b32 v[26:27], v9 offset0:146 offset1:147
    s_waitcnt lgkmcnt(15)
    v_mfma_f32_16x16x32_bf16 v[160:163], v[80:83], v[128:131], v[160:163]
    ds_read_b128 v[56:59], v12 offset:1088
    v_mfma_f32_16x16x32_bf16 v[160:163], v[96:99], v[112:115], v[160:163]
    ds_read2_b32 v[28:29], v9 offset0:16 offset1:17
    v_mfma_f32_16x16x32_bf16 v[164:167], v[84:87], v[128:131], v[164:167]
    ds_read2_b32 v[30:31], v9 offset0:18 offset1:19
    v_mfma_f32_16x16x32_bf16 v[164:167], v[96:99], v[116:119], v[164:167]
    ds_read_b128 v[60:63], v12 offset:1600
    v_mfma_f32_16x16x32_bf16 v[168:171], v[88:91], v[128:131], v[168:171]
    ds_read2_b32 v[32:33], v10 offset0:144 offset1:145
    v_mfma_f32_16x16x32_bf16 v[168:171], v[96:99], v[120:123], v[168:171]
    ds_read2_b32 v[34:35], v10 offset0:146 offset1:147
    v_mfma_f32_16x16x32_bf16 v[172:175], v[92:95], v[128:131], v[172:175]
    ds_read_b128 v[64:67], v12 offset:2112
    v_mfma_f32_16x16x32_bf16 v[172:175], v[96:99], v[124:127], v[172:175]
    ds_read2_b32 v[36:37], v10 offset0:16 offset1:17
    s_waitcnt lgkmcnt(15)
    v_mfma_f32_16x16x32_bf16 v[164:167], v[80:83], v[132:135], v[164:167]
    ds_read2_b32 v[38:39], v10 offset0:18 offset1:19
    v_mfma_f32_16x16x32_bf16 v[164:167], v[100:103], v[112:115], v[164:167]
    ds_read_b128 v[68:71], v12 offset:2624
    v_mfma_f32_16x16x32_bf16 v[168:171], v[84:87], v[132:135], v[168:171]
    ds_read2_b32 v[40:41], v11 offset0:144 offset1:145
    v_mfma_f32_16x16x32_bf16 v[168:171], v[100:103], v[116:119], v[168:171]
    ds_read2_b32 v[42:43], v11 offset0:146 offset1:147
    v_mfma_f32_16x16x32_bf16 v[172:175], v[88:91], v[132:135], v[172:175]
    ds_read_b128 v[72:75], v12 offset:3136
    v_mfma_f32_16x16x32_bf16 v[172:175], v[100:103], v[120:123], v[172:175]
    ds_read2_b32 v[44:45], v11 offset0:16 offset1:17
    s_waitcnt lgkmcnt(15)
    v_mfma_f32_16x16x32_bf16 v[168:171], v[80:83], v[136:139], v[168:171]
    ds_read2_b32 v[46:47], v11 offset0:18 offset1:19
    v_mfma_f32_16x16x32_bf16 v[168:171], v[104:107], v[112:115], v[168:171]
    ds_read_b128 v[76:79], v12 offset:3648
    v_mfma_f32_16x16x32_bf16 v[172:175], v[84:87], v[136:139], v[172:175]
    v_mfma_f32_16x16x32_bf16 v[172:175], v[104:107], v[116:119], v[172:175]
    s_waitcnt lgkmcnt(15)
    v_mfma_f32_16x16x32_bf16 v[172:175], v[80:83], v[140:143], v[172:175]
    v_mfma_f32_16x16x32_bf16 v[172:175], v[108:111], v[112:115], v[172:175]
    s_waitcnt lgkmcnt(15)
    v_mfma_f32_16x16x32_bf16 v[144:147], v[16:19], v[48:51], v[144:147]
    s_waitcnt lgkmcnt(15)
    v_mfma_f32_16x16x32_bf16 v[148:151], v[16:19], v[52:55], v[148:151]
    v_mfma_f32_16x16x32_bf16 v[148:151], v[20:23], v[48:51], v[148:151]
    v_mfma_f32_16x16x32_bf16 v[152:155], v[20:23], v[52:55], v[152:155]
    s_waitcnt lgkmcnt(15)
    v_mfma_f32_16x16x32_bf16 v[152:155], v[16:19], v[56:59], v[152:155]
    v_mfma_f32_16x16x32_bf16 v[152:155], v[24:27], v[48:51], v[152:155]
    v_mfma_f32_16x16x32_bf16 v[156:159], v[20:23], v[56:59], v[156:159]
    v_mfma_f32_16x16x32_bf16 v[156:159], v[24:27], v[52:55], v[156:159]
    v_mfma_f32_16x16x32_bf16 v[160:163], v[24:27], v[56:59], v[160:163]
    ds_read2_b32 v[80:81], v8 offset0:128 offset1:129
    s_waitcnt lgkmcnt(13)
    v_mfma_f32_16x16x32_bf16 v[156:159], v[16:19], v[60:63], v[156:159]
    ds_read2_b32 v[82:83], v8 offset0:130 offset1:131
    v_mfma_f32_16x16x32_bf16 v[156:159], v[28:31], v[48:51], v[156:159]
    ds_read_b128 v[112:115], v12 offset:0
    v_mfma_f32_16x16x32_bf16 v[160:163], v[20:23], v[60:63], v[160:163]
    ds_read2_b32 v[84:85], v8 offset0:0 offset1:1
    v_mfma_f32_16x16x32_bf16 v[160:163], v[28:31], v[52:55], v[160:163]
    ds_read2_b32 v[86:87], v8 offset0:2 offset1:3
    v_mfma_f32_16x16x32_bf16 v[164:167], v[24:27], v[60:63], v[164:167]
    ds_read_b128 v[116:119], v12 offset:512
    v_mfma_f32_16x16x32_bf16 v[164:167], v[28:31], v[56:59], v[164:167]
    ds_read2_b32 v[88:89], v9 offset0:128 offset1:129
    v_mfma_f32_16x16x32_bf16 v[168:171], v[28:31], v[60:63], v[168:171]
    ds_read2_b32 v[90:91], v9 offset0:130 offset1:131
    s_waitcnt lgkmcnt(15)
    v_mfma_f32_16x16x32_bf16 v[160:163], v[16:19], v[64:67], v[160:163]
    ds_read_b128 v[120:123], v12 offset:1024
    v_mfma_f32_16x16x32_bf16 v[160:163], v[32:35], v[48:51], v[160:163]
    ds_read2_b32 v[92:93], v9 offset0:0 offset1:1
    v_mfma_f32_16x16x32_bf16 v[164:167], v[20:23], v[64:67], v[164:167]
    ds_read2_b32 v[94:95], v9 offset0:2 offset1:3
    v_mfma_f32_16x16x32_bf16 v[164:167], v[32:35], v[52:55], v[164:167]
    ds_read_b128 v[124:127], v12 offset:1536
    v_mfma_f32_16x16x32_bf16 v[168:171], v[24:27], v[64:67], v[168:171]
    ds_read2_b32 v[96:97], v10 offset0:128 offset1:129
    v_mfma_f32_16x16x32_bf16 v[168:171], v[32:35], v[56:59], v[168:171]
    ds_read2_b32 v[98:99], v10 offset0:130 offset1:131
    v_mfma_f32_16x16x32_bf16 v[172:175], v[28:31], v[64:67], v[172:175]
    ds_read_b128 v[128:131], v12 offset:2048
    v_mfma_f32_16x16x32_bf16 v[172:175], v[32:35], v[60:63], v[172:175]
    ds_read2_b32 v[100:101], v10 offset0:0 offset1:1
    s_waitcnt lgkmcnt(15)
    v_mfma_f32_16x16x32_bf16 v[164:167], v[16:19], v[68:71], v[164:167]
    ds_read2_b32 v[102:103], v10 offset0:2 offset1:3
    v_mfma_f32_16x16x32_bf16 v[164:167], v[36:39], v[48:51], v[164:167]
    ds_read_b128 v[132:135], v12 offset:2560
    v_mfma_f32_16x16x32_bf16 v[168:171], v[20:23], v[68:71], v[168:171]
    ds_read2_b32 v[104:105], v11 offset0:128 offset1:129
    v_mfma_f32_16x16x32_bf16 v[168:171], v[36:39], v[52:55], v[168:171]
    ds_read2_b32 v[106:107], v11 offset0:130 offset1:131
    v_mfma_f32_16x16x32_bf16 v[172:175], v[24:27], v[68:71], v[172:175]
    ds_read_b128 v[136:139], v12 offset:3072
    v_mfma_f32_16x16x32_bf16 v[172:175], v[36:39], v[56:59], v[172:175]
    ds_read2_b32 v[108:109], v11 offset0:0 offset1:1
    s_waitcnt lgkmcnt(15)
    v_mfma_f32_16x16x32_bf16 v[168:171], v[16:19], v[72:75], v[168:171]
    ds_read2_b32 v[110:111], v11 offset0:2 offset1:3
    v_mfma_f32_16x16x32_bf16 v[168:171], v[40:43], v[48:51], v[168:171]
    ds_read_b128 v[140:143], v12 offset:3584
    v_mfma_f32_16x16x32_bf16 v[172:175], v[20:23], v[72:75], v[172:175]
    v_mfma_f32_16x16x32_bf16 v[172:175], v[40:43], v[52:55], v[172:175]
    s_waitcnt lgkmcnt(15)
    v_mfma_f32_16x16x32_bf16 v[172:175], v[16:19], v[76:79], v[172:175]
    v_mfma_f32_16x16x32_bf16 v[172:175], v[44:47], v[48:51], v[172:175]
    s_waitcnt lgkmcnt(15)
    v_mfma_f32_16x16x32_bf16 v[144:147], v[80:83], v[112:115], v[144:147]
    s_waitcnt lgkmcnt(15)
    v_mfma_f32_16x16x32_bf16 v[148:151], v[80:83], v[116:119], v[148:151]
    v_mfma_f32_16x16x32_bf16 v[148:151], v[84:87], v[112:115], v[148:151]
    v_mfma_f32_16x16x32_bf16 v[152:155], v[84:87], v[116:119], v[152:155]
    s_waitcnt lgkmcnt(15)
    v_mfma_f32_16x16x32_bf16 v[152:155], v[80:83], v[120:123], v[152:155]
    v_mfma_f32_16x16x32_bf16 v[152:155], v[88:91], v[112:115], v[152:155]
    v_mfma_f32_16x16x32_bf16 v[156:159], v[84:87], v[120:123], v[156:159]
    v_mfma_f32_16x16x32_bf16 v[156:159], v[88:91], v[116:119], v[156:159]
    v_mfma_f32_16x16x32_bf16 v[160:163], v[88:91], v[120:123], v[160:163]
    s_waitcnt lgkmcnt(12)
    v_mfma_f32_16x16x32_bf16 v[156:159], v[80:83], v[124:127], v[156:159]
    v_mfma_f32_16x16x32_bf16 v[156:159], v[92:95], v[112:115], v[156:159]
    v_mfma_f32_16x16x32_bf16 v[160:163], v[84:87], v[124:127], v[160:163]
    v_mfma_f32_16x16x32_bf16 v[160:163], v[92:95], v[116:119], v[160:163]
    v_mfma_f32_16x16x32_bf16 v[164:167], v[88:91], v[124:127], v[164:167]
    v_mfma_f32_16x16x32_bf16 v[164:167], v[92:95], v[120:123], v[164:167]
    v_mfma_f32_16x16x32_bf16 v[168:171], v[92:95], v[124:127], v[168:171]
    s_waitcnt lgkmcnt(9)
    v_mfma_f32_16x16x32_bf16 v[160:163], v[80:83], v[128:131], v[160:163]
    v_mfma_f32_16x16x32_bf16 v[160:163], v[96:99], v[112:115], v[160:163]
    v_mfma_f32_16x16x32_bf16 v[164:167], v[84:87], v[128:131], v[164:167]
    v_mfma_f32_16x16x32_bf16 v[164:167], v[96:99], v[116:119], v[164:167]
    v_mfma_f32_16x16x32_bf16 v[168:171], v[88:91], v[128:131], v[168:171]
    v_mfma_f32_16x16x32_bf16 v[168:171], v[96:99], v[120:123], v[168:171]
    v_mfma_f32_16x16x32_bf16 v[172:175], v[92:95], v[128:131], v[172:175]
    v_mfma_f32_16x16x32_bf16 v[172:175], v[96:99], v[124:127], v[172:175]
    s_waitcnt lgkmcnt(6)
    v_mfma_f32_16x16x32_bf16 v[164:167], v[80:83], v[132:135], v[164:167]
    v_mfma_f32_16x16x32_bf16 v[164:167], v[100:103], v[112:115], v[164:167]
    v_mfma_f32_16x16x32_bf16 v[168:171], v[84:87], v[132:135], v[168:171]
    v_mfma_f32_16x16x32_bf16 v[168:171], v[100:103], v[116:119], v[168:171]
    v_mfma_f32_16x16x32_bf16 v[172:175], v[88:91], v[132:135], v[172:175]
    v_mfma_f32_16x16x32_bf16 v[172:175], v[100:103], v[120:123], v[172:175]
    s_waitcnt lgkmcnt(3)
    v_mfma_f32_16x16x32_bf16 v[168:171], v[80:83], v[136:139], v[168:171]
    v_mfma_f32_16x16x32_bf16 v[168:171], v[104:107], v[112:115], v[168:171]
    v_mfma_f32_16x16x32_bf16 v[172:175], v[84:87], v[136:139], v[172:175]
    v_mfma_f32_16x16x32_bf16 v[172:175], v[104:107], v[116:119], v[172:175]
    s_waitcnt lgkmcnt(0)
    v_mfma_f32_16x16x32_bf16 v[172:175], v[80:83], v[140:143], v[172:175]
    v_mfma_f32_16x16x32_bf16 v[172:175], v[108:111], v[112:115], v[172:175]
    s_setprio 2
    ds_read_b64 v[80:81], v13 offset:0
    ds_read_b64 v[82:83], v13 offset:512
    ds_read_b64 v[84:85], v13 offset:1024
    ds_read_b64 v[86:87], v13 offset:1536
    s_cmp_eq_u32 s27, 1
    s_nop 2
    s_cbranch_scc1 B_R1
    ds_write_b128 v242, v[160:163] offset:0
    ds_write_b128 v242, v[164:167] offset:1024
    ds_write_b128 v242, v[168:171] offset:2048
    ds_write_b128 v242, v[172:175] offset:3072
    s_waitcnt lgkmcnt(0)
    s_barrier
    ds_read_b128 v[16:19], v243 offset:0
    ds_read_b128 v[20:23], v243 offset:1024
    ds_read_b128 v[24:27], v243 offset:2048
    ds_read_b128 v[28:31], v243 offset:3072
    s_waitcnt lgkmcnt(0)
    v_add_f32 v16, v16, v144
    v_add_f32 v17, v17, v145
    v_add_f32 v18, v18, v146
    v_add_f32 v19, v19, v147
    v_add_f32 v20, v20, v148
    v_add_f32 v21, v21, v149
    v_add_f32 v22, v22, v150
    v_add_f32 v23, v23, v151
    v_add_f32 v24, v24, v152
    v_add_f32 v25, v25, v153
    v_add_f32 v26, v26, v154
    v_add_f32 v27, v27, v155
    v_add_f32 v28, v28, v156
    v_add_f32 v29, v29, v157
    v_add_f32 v30, v30, v158
    v_add_f32 v31, v31, v159
    s_branch B_R2
B_R1:
    ds_write_b128 v242, v[144:147] offset:0
    ds_write_b128 v242, v[148:151] offset:1024
    ds_write_b128 v242, v[152:155] offset:2048
    ds_write_b128 v242, v[156:159] offset:3072
    s_waitcnt lgkmcnt(0)
    s_barrier
    ds_read_b128 v[16:19], v243 offset:0
    ds_read_b128 v[20:23], v243 offset:1024
    ds_read_b128 v[24:27], v243 offset:2048
    ds_read_b128 v[28:31], v243 offset:3072
    s_waitcnt lgkmcnt(0)
    v_add_f32 v16, v16, v160
    v_add_f32 v17, v17, v161
    v_add_f32 v18, v18, v162
    v_add_f32 v19, v19, v163
    v_add_f32 v20, v20, v164
    v_add_f32 v21, v21, v165
    v_add_f32 v22, v22, v166
    v_add_f32 v23, v23, v167
    v_add_f32 v24, v24, v168
    v_add_f32 v25, v25, v169
    v_add_f32 v26, v26, v170
    v_add_f32 v27, v27, v171
    v_add_f32 v28, v28, v172
    v_add_f32 v29, v29, v173
    v_add_f32 v30, v30, v174
    v_add_f32 v31, v31, v175
B_R2:
    v_lshlrev_b32 v88, 16, v80
    v_and_b32 v89, 0xffff0000, v80
    v_lshlrev_b32 v90, 16, v81
    v_and_b32 v91, 0xffff0000, v81
    v_fmac_f32 v16, s38, v88
    v_fmac_f32 v17, s38, v89
    v_fmac_f32 v18, s38, v90
    v_fmac_f32 v19, s38, v91
    v_cvt_pk_bf16_f32 v80, v16, v17
    v_cvt_pk_bf16_f32 v81, v18, v19
    v_lshlrev_b32 v88, 16, v82
    v_and_b32 v89, 0xffff0000, v82
    v_lshlrev_b32 v90, 16, v83
    v_and_b32 v91, 0xffff0000, v83
    v_fmac_f32 v20, s38, v88
    v_fmac_f32 v21, s38, v89
    v_fmac_f32 v22, s38, v90
    v_fmac_f32 v23, s38, v91
    v_cvt_pk_bf16_f32 v82, v20, v21
    v_cvt_pk_bf16_f32 v83, v22, v23
    v_lshlrev_b32 v88, 16, v84
    v_and_b32 v89, 0xffff0000, v84
    v_lshlrev_b32 v90, 16, v85
    v_and_b32 v91, 0xffff0000, v85
    v_fmac_f32 v24, s38, v88
    v_fmac_f32 v25, s38, v89
    v_fmac_f32 v26, s38, v90
    v_fmac_f32 v27, s38, v91
    v_cvt_pk_bf16_f32 v84, v24, v25
    v_cvt_pk_bf16_f32 v85, v26, v27
    v_lshlrev_b32 v88, 16, v86
    v_and_b32 v89, 0xffff0000, v86
    v_lshlrev_b32 v90, 16, v87
    v_and_b32 v91, 0xffff0000, v87
    v_fmac_f32 v28, s38, v88
    v_fmac_f32 v29, s38, v89
    v_fmac_f32 v30, s38, v90
    v_fmac_f32 v31, s38, v91
    v_cvt_pk_bf16_f32 v86, v28, v29
    v_cvt_pk_bf16_f32 v87, v30, v31
    s_nop 1
    v_permlane16_swap_b32 v80, v82
    v_permlane16_swap_b32 v81, v83
    v_permlane16_swap_b32 v84, v86
    v_permlane16_swap_b32 v85, v87
    buffer_store_dwordx4 v[80:83], v2, s[20:23], s41 offen offset:0 sc1
    buffer_store_dwordx4 v[84:87], v2, s[20:23], s41 offen offset:1024 sc1
    s_waitcnt vmcnt(0)
    v_mov_b32 v4, 1
    s_mov_b64 exec, 1
    buffer_atomic_add v4, v255, s[20:23], s40 offen sc1
    s_mov_b64 exec, -1
    s_endpgm
L_C:
    s_setprio 0
    s_sub_u32 s25, s2, 224
    s_lshl_b32 s26, s31, 2
    s_sub_u32 s33, s32, 28
    s_add_u32 s26, s26, s33
    s_lshl_b32 s26, s26, 2
    s_add_u32 s26, s26, s24
    s_mul_i32 s36, s26, 14336
    s_add_u32 s37, s36, 3584
    s_add_u32 s38, s36, 7168
    s_add_u32 s39, s36, 10752
    s_add_u32 s45, s25, s24
    s_waitcnt lgkmcnt(0)
    s_mov_b32 s20, s94
    s_mov_b32 s21, s95
    s_mov_b32 s22, 11075584
    s_mov_b32 s23, 0x00020000
    s_mov_b32 s12, s64
    s_mov_b32 s13, s65
    s_mov_b32 s14, 1835008
    s_mov_b32 s15, 0x00020000
    buffer_load_dwordx4 v[16:19], v2, s[12:15], s36 offen offset:0
    buffer_load_dwordx4 v[20:23], v2, s[12:15], s36 offen offset:896
    buffer_load_dwordx4 v[24:27], v2, s[12:15], s36 offen offset:1792
    buffer_load_dwordx4 v[28:31], v2, s[12:15], s36 offen offset:2688
    buffer_load_dwordx4 v[32:35], v2, s[12:15], s37 offen offset:0
    buffer_load_dwordx4 v[36:39], v2, s[12:15], s37 offen offset:896
    buffer_load_dwordx4 v[40:43], v2, s[12:15], s37 offen offset:1792
    buffer_load_dwordx4 v[44:47], v2, s[12:15], s37 offen offset:2688
    buffer_load_dwordx4 v[48:51], v2, s[12:15], s38 offen offset:0
    buffer_load_dwordx4 v[52:55], v2, s[12:15], s38 offen offset:896
    buffer_load_dwordx4 v[56:59], v2, s[12:15], s38 offen offset:1792
    buffer_load_dwordx4 v[60:63], v2, s[12:15], s38 offen offset:2688
    buffer_load_dwordx4 v[64:67], v2, s[12:15], s39 offen offset:0
    buffer_load_dwordx4 v[68:71], v2, s[12:15], s39 offen offset:896
    buffer_load_dwordx4 v[72:75], v2, s[12:15], s39 offen offset:1792
    buffer_load_dwordx4 v[76:79], v2, s[12:15], s39 offen offset:2688
    s_mov_b32 s16, s88
    s_mov_b32 s17, s89
    s_mov_b32 s18, 896
    s_mov_b32 s19, 0x00020000
    buffer_load_dwordx4 v[160:163], v2, s[16:19], 0 offen
    v_mov_b32 v144, 0
    v_mov_b32 v145, 0
    v_mov_b32 v146, 0
    v_mov_b32 v147, 0
    v_mov_b32 v148, 0
    v_mov_b32 v149, 0
    v_mov_b32 v150, 0
    v_mov_b32 v151, 0
    v_mov_b32 v152, 0
    v_mov_b32 v153, 0
    v_mov_b32 v154, 0
    v_mov_b32 v155, 0
    v_mov_b32 v156, 0
    v_mov_b32 v157, 0
    v_mov_b32 v158, 0
    v_mov_b32 v159, 0
    s_mov_b32 exec_hi, 0xffffff
    s_waitcnt vmcnt(0)
    v_dot2c_f32_bf16 v144, v16, v160
    v_dot2c_f32_bf16 v145, v20, v160
    v_dot2c_f32_bf16 v146, v24, v160
    v_dot2c_f32_bf16 v147, v28, v160
    v_dot2c_f32_bf16 v148, v32, v160
    v_dot2c_f32_bf16 v149, v36, v160
    v_dot2c_f32_bf16 v150, v40, v160
    v_dot2c_f32_bf16 v151, v44, v160
    v_dot2c_f32_bf16 v152, v48, v160
    v_dot2c_f32_bf16 v153, v52, v160
    v_dot2c_f32_bf16 v154, v56, v160
    v_dot2c_f32_bf16 v155, v60, v160
    v_dot2c_f32_bf16 v156, v64, v160
    v_dot2c_f32_bf16 v157, v68, v160
    v_dot2c_f32_bf16 v158, v72, v160
    v_dot2c_f32_bf16 v159, v76, v160
    v_dot2c_f32_bf16 v144, v17, v161
    v_dot2c_f32_bf16 v145, v21, v161
    v_dot2c_f32_bf16 v146, v25, v161
    v_dot2c_f32_bf16 v147, v29, v161
    v_dot2c_f32_bf16 v148, v33, v161
    v_dot2c_f32_bf16 v149, v37, v161
    v_dot2c_f32_bf16 v150, v41, v161
    v_dot2c_f32_bf16 v151, v45, v161
    v_dot2c_f32_bf16 v152, v49, v161
    v_dot2c_f32_bf16 v153, v53, v161
    v_dot2c_f32_bf16 v154, v57, v161
    v_dot2c_f32_bf16 v155, v61, v161
    v_dot2c_f32_bf16 v156, v65, v161
    v_dot2c_f32_bf16 v157, v69, v161
    v_dot2c_f32_bf16 v158, v73, v161
    v_dot2c_f32_bf16 v159, v77, v161
    v_dot2c_f32_bf16 v144, v18, v162
    v_dot2c_f32_bf16 v145, v22, v162
    v_dot2c_f32_bf16 v146, v26, v162
    v_dot2c_f32_bf16 v147, v30, v162
    v_dot2c_f32_bf16 v148, v34, v162
    v_dot2c_f32_bf16 v149, v38, v162
    v_dot2c_f32_bf16 v150, v42, v162
    v_dot2c_f32_bf16 v151, v46, v162
    v_dot2c_f32_bf16 v152, v50, v162
    v_dot2c_f32_bf16 v153, v54, v162
    v_dot2c_f32_bf16 v154, v58, v162
    v_dot2c_f32_bf16 v155, v62, v162
    v_dot2c_f32_bf16 v156, v66, v162
    v_dot2c_f32_bf16 v157, v70, v162
    v_dot2c_f32_bf16 v158, v74, v162
    v_dot2c_f32_bf16 v159, v78, v162
    v_dot2c_f32_bf16 v144, v19, v163
    v_dot2c_f32_bf16 v145, v23, v163
    v_dot2c_f32_bf16 v146, v27, v163
    v_dot2c_f32_bf16 v147, v31, v163
    v_dot2c_f32_bf16 v148, v35, v163
    v_dot2c_f32_bf16 v149, v39, v163
    v_dot2c_f32_bf16 v150, v43, v163
    v_dot2c_f32_bf16 v151, v47, v163
    v_dot2c_f32_bf16 v152, v51, v163
    v_dot2c_f32_bf16 v153, v55, v163
    v_dot2c_f32_bf16 v154, v59, v163
    v_dot2c_f32_bf16 v155, v63, v163
    v_dot2c_f32_bf16 v156, v67, v163
    v_dot2c_f32_bf16 v157, v71, v163
    v_dot2c_f32_bf16 v158, v75, v163
    v_dot2c_f32_bf16 v159, v79, v163
    s_mov_b64 exec, -1
    s_min_u32 s45, s25, 15
    s_mul_i32 s33, s45, 25088
    s_mul_i32 s34, s24, 7168
    s_add_u32 s33, s33, s34
    v_add_u32 v3, 4096, v2
    s_mov_b32 s12, s68
    s_mov_b32 s13, s69
    s_mov_b32 s14, 401408
    s_mov_b32 s15, 0x00020000
    s_mov_b32 m0, s34
    s_nop 0
    buffer_load_dwordx4 v2, s[12:15], s33 offen offset:0 lds
    buffer_load_dwordx4 v2, s[12:15], s33 offen offset:1024 lds
    buffer_load_dwordx4 v2, s[12:15], s33 offen offset:2048 lds
    buffer_load_dwordx4 v2, s[12:15], s33 offen offset:3072 lds
    s_add_u32 m0, s34, 4096
    s_nop 0
    buffer_load_dwordx4 v3, s[12:15], s33 offen offset:0 lds
    buffer_load_dwordx4 v3, s[12:15], s33 offen offset:1024 lds
    buffer_load_dwordx4 v3, s[12:15], s33 offen offset:2048 lds
    v_add_f32_dpp v144, v144, v144 row_shr:1 row_mask:0xf bank_mask:0xf bound_ctrl:0
    v_add_f32_dpp v145, v145, v145 row_shr:1 row_mask:0xf bank_mask:0xf bound_ctrl:0
    v_add_f32_dpp v146, v146, v146 row_shr:1 row_mask:0xf bank_mask:0xf bound_ctrl:0
    v_add_f32_dpp v147, v147, v147 row_shr:1 row_mask:0xf bank_mask:0xf bound_ctrl:0
    v_add_f32_dpp v148, v148, v148 row_shr:1 row_mask:0xf bank_mask:0xf bound_ctrl:0
    v_add_f32_dpp v149, v149, v149 row_shr:1 row_mask:0xf bank_mask:0xf bound_ctrl:0
    v_add_f32_dpp v150, v150, v150 row_shr:1 row_mask:0xf bank_mask:0xf bound_ctrl:0
    v_add_f32_dpp v151, v151, v151 row_shr:1 row_mask:0xf bank_mask:0xf bound_ctrl:0
    v_add_f32_dpp v152, v152, v152 row_shr:1 row_mask:0xf bank_mask:0xf bound_ctrl:0
    v_add_f32_dpp v153, v153, v153 row_shr:1 row_mask:0xf bank_mask:0xf bound_ctrl:0
    v_add_f32_dpp v154, v154, v154 row_shr:1 row_mask:0xf bank_mask:0xf bound_ctrl:0
    v_add_f32_dpp v155, v155, v155 row_shr:1 row_mask:0xf bank_mask:0xf bound_ctrl:0
    v_add_f32_dpp v156, v156, v156 row_shr:1 row_mask:0xf bank_mask:0xf bound_ctrl:0
    v_add_f32_dpp v157, v157, v157 row_shr:1 row_mask:0xf bank_mask:0xf bound_ctrl:0
    v_add_f32_dpp v158, v158, v158 row_shr:1 row_mask:0xf bank_mask:0xf bound_ctrl:0
    v_add_f32_dpp v159, v159, v159 row_shr:1 row_mask:0xf bank_mask:0xf bound_ctrl:0
    v_add_f32_dpp v144, v144, v144 row_shr:2 row_mask:0xf bank_mask:0xf bound_ctrl:0
    v_add_f32_dpp v145, v145, v145 row_shr:2 row_mask:0xf bank_mask:0xf bound_ctrl:0
    v_add_f32_dpp v146, v146, v146 row_shr:2 row_mask:0xf bank_mask:0xf bound_ctrl:0
    v_add_f32_dpp v147, v147, v147 row_shr:2 row_mask:0xf bank_mask:0xf bound_ctrl:0
    v_add_f32_dpp v148, v148, v148 row_shr:2 row_mask:0xf bank_mask:0xf bound_ctrl:0
    v_add_f32_dpp v149, v149, v149 row_shr:2 row_mask:0xf bank_mask:0xf bound_ctrl:0
    v_add_f32_dpp v150, v150, v150 row_shr:2 row_mask:0xf bank_mask:0xf bound_ctrl:0
    v_add_f32_dpp v151, v151, v151 row_shr:2 row_mask:0xf bank_mask:0xf bound_ctrl:0
    v_add_f32_dpp v152, v152, v152 row_shr:2 row_mask:0xf bank_mask:0xf bound_ctrl:0
    v_add_f32_dpp v153, v153, v153 row_shr:2 row_mask:0xf bank_mask:0xf bound_ctrl:0
    v_add_f32_dpp v154, v154, v154 row_shr:2 row_mask:0xf bank_mask:0xf bound_ctrl:0
    v_add_f32_dpp v155, v155, v155 row_shr:2 row_mask:0xf bank_mask:0xf bound_ctrl:0
    v_add_f32_dpp v156, v156, v156 row_shr:2 row_mask:0xf bank_mask:0xf bound_ctrl:0
    v_add_f32_dpp v157, v157, v157 row_shr:2 row_mask:0xf bank_mask:0xf bound_ctrl:0
    v_add_f32_dpp v158, v158, v158 row_shr:2 row_mask:0xf bank_mask:0xf bound_ctrl:0
    v_add_f32_dpp v159, v159, v159 row_shr:2 row_mask:0xf bank_mask:0xf bound_ctrl:0
    v_add_f32_dpp v144, v144, v144 row_shr:4 row_mask:0xf bank_mask:0xf bound_ctrl:0
    v_add_f32_dpp v145, v145, v145 row_shr:4 row_mask:0xf bank_mask:0xf bound_ctrl:0
    v_add_f32_dpp v146, v146, v146 row_shr:4 row_mask:0xf bank_mask:0xf bound_ctrl:0
    v_add_f32_dpp v147, v147, v147 row_shr:4 row_mask:0xf bank_mask:0xf bound_ctrl:0
    v_add_f32_dpp v148, v148, v148 row_shr:4 row_mask:0xf bank_mask:0xf bound_ctrl:0
    v_add_f32_dpp v149, v149, v149 row_shr:4 row_mask:0xf bank_mask:0xf bound_ctrl:0
    v_add_f32_dpp v150, v150, v150 row_shr:4 row_mask:0xf bank_mask:0xf bound_ctrl:0
    v_add_f32_dpp v151, v151, v151 row_shr:4 row_mask:0xf bank_mask:0xf bound_ctrl:0
    v_add_f32_dpp v152, v152, v152 row_shr:4 row_mask:0xf bank_mask:0xf bound_ctrl:0
    v_add_f32_dpp v153, v153, v153 row_shr:4 row_mask:0xf bank_mask:0xf bound_ctrl:0
    v_add_f32_dpp v154, v154, v154 row_shr:4 row_mask:0xf bank_mask:0xf bound_ctrl:0
    v_add_f32_dpp v155, v155, v155 row_shr:4 row_mask:0xf bank_mask:0xf bound_ctrl:0
    v_add_f32_dpp v156, v156, v156 row_shr:4 row_mask:0xf bank_mask:0xf bound_ctrl:0
    v_add_f32_dpp v157, v157, v157 row_shr:4 row_mask:0xf bank_mask:0xf bound_ctrl:0
    v_add_f32_dpp v158, v158, v158 row_shr:4 row_mask:0xf bank_mask:0xf bound_ctrl:0
    v_add_f32_dpp v159, v159, v159 row_shr:4 row_mask:0xf bank_mask:0xf bound_ctrl:0
    v_add_f32_dpp v144, v144, v144 row_shr:8 row_mask:0xf bank_mask:0xf bound_ctrl:0
    v_add_f32_dpp v145, v145, v145 row_shr:8 row_mask:0xf bank_mask:0xf bound_ctrl:0
    v_add_f32_dpp v146, v146, v146 row_shr:8 row_mask:0xf bank_mask:0xf bound_ctrl:0
    v_add_f32_dpp v147, v147, v147 row_shr:8 row_mask:0xf bank_mask:0xf bound_ctrl:0
    v_add_f32_dpp v148, v148, v148 row_shr:8 row_mask:0xf bank_mask:0xf bound_ctrl:0
    v_add_f32_dpp v149, v149, v149 row_shr:8 row_mask:0xf bank_mask:0xf bound_ctrl:0
    v_add_f32_dpp v150, v150, v150 row_shr:8 row_mask:0xf bank_mask:0xf bound_ctrl:0
    v_add_f32_dpp v151, v151, v151 row_shr:8 row_mask:0xf bank_mask:0xf bound_ctrl:0
    v_add_f32_dpp v152, v152, v152 row_shr:8 row_mask:0xf bank_mask:0xf bound_ctrl:0
    v_add_f32_dpp v153, v153, v153 row_shr:8 row_mask:0xf bank_mask:0xf bound_ctrl:0
    v_add_f32_dpp v154, v154, v154 row_shr:8 row_mask:0xf bank_mask:0xf bound_ctrl:0
    v_add_f32_dpp v155, v155, v155 row_shr:8 row_mask:0xf bank_mask:0xf bound_ctrl:0
    v_add_f32_dpp v156, v156, v156 row_shr:8 row_mask:0xf bank_mask:0xf bound_ctrl:0
    v_add_f32_dpp v157, v157, v157 row_shr:8 row_mask:0xf bank_mask:0xf bound_ctrl:0
    v_add_f32_dpp v158, v158, v158 row_shr:8 row_mask:0xf bank_mask:0xf bound_ctrl:0
    v_add_f32_dpp v159, v159, v159 row_shr:8 row_mask:0xf bank_mask:0xf bound_ctrl:0
    v_add_f32_dpp v144, v144, v144 row_bcast:15 row_mask:0xa bank_mask:0xf
    v_add_f32_dpp v145, v145, v145 row_bcast:15 row_mask:0xa bank_mask:0xf
    v_add_f32_dpp v146, v146, v146 row_bcast:15 row_mask:0xa bank_mask:0xf
    v_add_f32_dpp v147, v147, v147 row_bcast:15 row_mask:0xa bank_mask:0xf
    v_add_f32_dpp v148, v148, v148 row_bcast:15 row_mask:0xa bank_mask:0xf
    v_add_f32_dpp v149, v149, v149 row_bcast:15 row_mask:0xa bank_mask:0xf
    v_add_f32_dpp v150, v150, v150 row_bcast:15 row_mask:0xa bank_mask:0xf
    v_add_f32_dpp v151, v151, v151 row_bcast:15 row_mask:0xa bank_mask:0xf
    v_add_f32_dpp v152, v152, v152 row_bcast:15 row_mask:0xa bank_mask:0xf
    v_add_f32_dpp v153, v153, v153 row_bcast:15 row_mask:0xa bank_mask:0xf
    v_add_f32_dpp v154, v154, v154 row_bcast:15 row_mask:0xa bank_mask:0xf
    v_add_f32_dpp v155, v155, v155 row_bcast:15 row_mask:0xa bank_mask:0xf
    v_add_f32_dpp v156, v156, v156 row_bcast:15 row_mask:0xa bank_mask:0xf
    v_add_f32_dpp v157, v157, v157 row_bcast:15 row_mask:0xa bank_mask:0xf
    v_add_f32_dpp v158, v158, v158 row_bcast:15 row_mask:0xa bank_mask:0xf
    v_add_f32_dpp v159, v159, v159 row_bcast:15 row_mask:0xa bank_mask:0xf
    v_add_f32_dpp v144, v144, v144 row_bcast:31 row_mask:0xc bank_mask:0xf
    v_add_f32_dpp v145, v145, v145 row_bcast:31 row_mask:0xc bank_mask:0xf
    v_add_f32_dpp v146, v146, v146 row_bcast:31 row_mask:0xc bank_mask:0xf
    v_add_f32_dpp v147, v147, v147 row_bcast:31 row_mask:0xc bank_mask:0xf
    v_add_f32_dpp v148, v148, v148 row_bcast:31 row_mask:0xc bank_mask:0xf
    v_add_f32_dpp v149, v149, v149 row_bcast:31 row_mask:0xc bank_mask:0xf
    v_add_f32_dpp v150, v150, v150 row_bcast:31 row_mask:0xc bank_mask:0xf
    v_add_f32_dpp v151, v151, v151 row_bcast:31 row_mask:0xc bank_mask:0xf
    v_add_f32_dpp v152, v152, v152 row_bcast:31 row_mask:0xc bank_mask:0xf
    v_add_f32_dpp v153, v153, v153 row_bcast:31 row_mask:0xc bank_mask:0xf
    v_add_f32_dpp v154, v154, v154 row_bcast:31 row_mask:0xc bank_mask:0xf
    v_add_f32_dpp v155, v155, v155 row_bcast:31 row_mask:0xc bank_mask:0xf
    v_add_f32_dpp v156, v156, v156 row_bcast:31 row_mask:0xc bank_mask:0xf
    v_add_f32_dpp v157, v157, v157 row_bcast:31 row_mask:0xc bank_mask:0xf
    v_add_f32_dpp v158, v158, v158 row_bcast:31 row_mask:0xc bank_mask:0xf
    v_add_f32_dpp v159, v159, v159 row_bcast:31 row_mask:0xc bank_mask:0xf
    v_mul_f32 v144, 0xbfb8aa3b, v144
    v_mul_f32 v145, 0xbfb8aa3b, v145
    v_mul_f32 v146, 0xbfb8aa3b, v146
    v_mul_f32 v147, 0xbfb8aa3b, v147
    v_mul_f32 v148, 0xbfb8aa3b, v148
    v_mul_f32 v149, 0xbfb8aa3b, v149
    v_mul_f32 v150, 0xbfb8aa3b, v150
    v_mul_f32 v151, 0xbfb8aa3b, v151
    v_mul_f32 v152, 0xbfb8aa3b, v152
    v_mul_f32 v153, 0xbfb8aa3b, v153
    v_mul_f32 v154, 0xbfb8aa3b, v154
    v_mul_f32 v155, 0xbfb8aa3b, v155
    v_mul_f32 v156, 0xbfb8aa3b, v156
    v_mul_f32 v157, 0xbfb8aa3b, v157
    v_mul_f32 v158, 0xbfb8aa3b, v158
    v_mul_f32 v159, 0xbfb8aa3b, v159
    v_exp_f32 v144, v144
    v_exp_f32 v145, v145
    v_exp_f32 v146, v146
    v_exp_f32 v147, v147
    v_exp_f32 v148, v148
    v_exp_f32 v149, v149
    v_exp_f32 v150, v150
    v_exp_f32 v151, v151
    v_exp_f32 v152, v152
    v_exp_f32 v153, v153
    v_exp_f32 v154, v154
    v_exp_f32 v155, v155
    v_exp_f32 v156, v156
    v_exp_f32 v157, v157
    v_exp_f32 v158, v158
    v_exp_f32 v159, v159
    v_add_f32 v144, 1.0, v144
    v_add_f32 v145, 1.0, v145
    v_add_f32 v146, 1.0, v146
    v_add_f32 v147, 1.0, v147
    v_add_f32 v148, 1.0, v148
    v_add_f32 v149, 1.0, v149
    v_add_f32 v150, 1.0, v150
    v_add_f32 v151, 1.0, v151
    v_add_f32 v152, 1.0, v152
    v_add_f32 v153, 1.0, v153
    v_add_f32 v154, 1.0, v154
    v_add_f32 v155, 1.0, v155
    v_add_f32 v156, 1.0, v156
    v_add_f32 v157, 1.0, v157
    v_add_f32 v158, 1.0, v158
    v_add_f32 v159, 1.0, v159
    v_rcp_f32 v144, v144
    v_rcp_f32 v145, v145
    v_rcp_f32 v146, v146
    v_rcp_f32 v147, v147
    v_rcp_f32 v148, v148
    v_rcp_f32 v149, v149
    v_rcp_f32 v150, v150
    v_rcp_f32 v151, v151
    v_rcp_f32 v152, v152
    v_rcp_f32 v153, v153
    v_rcp_f32 v154, v154
    v_rcp_f32 v155, v155
    v_rcp_f32 v156, v156
    v_rcp_f32 v157, v157
    v_rcp_f32 v158, v158
    v_rcp_f32 v159, v159
    s_lshl_b32 s35, s26, 6
    s_add_u32 s35, s35, 6094848
    s_lshr_b32 s37, s26, 1
    s_lshl_b32 s37, s37, 7
    s_add_u32 s37, s37, 6803456
    s_mov_b32 exec_lo, 0
    s_mov_b32 exec_hi, 0x80000000
    buffer_store_dwordx4 v[144:147], v255, s[20:23], s35 offen offset:0 sc1
    buffer_store_dwordx4 v[148:151], v255, s[20:23], s35 offen offset:16 sc1
    buffer_store_dwordx4 v[152:155], v255, s[20:23], s35 offen offset:32 sc1
    buffer_store_dwordx4 v[156:159], v255, s[20:23], s35 offen offset:48 sc1
    s_mov_b64 exec, -1
    global_load_dword v250, v255, s[92:93] sc1
NI14:
    v_lshrrev_b32 v15, 5, v1
    v_bfe_u32 v13, v1, 2, 2
    v_lshl_add_u32 v13, v15, 2, v13
    v_mul_u32_u24 v13, 896, v13
    v_bfe_u32 v14, v1, 4, 1
    v_lshl_add_u32 v13, v14, 5, v13
    v_and_b32 v14, 3, v1
    v_lshl_add_u32 v12, v14, 3, v13
    s_lshr_b32 s49, s24, 1
    s_mul_i32 s36, s49, 14336
    s_mul_i32 s38, s27, 448
    s_add_u32 s36, s36, s38
    v_add_u32 v12, s36, v12
    s_mul_i32 s38, s27, 229376
    s_lshl_b32 s39, s45, 1
    s_add_u32 s39, s39, s49
    s_lshl_b32 s39, s39, 10
    s_add_u32 s38, s38, s39
    s_add_u32 s38, s38, 6291456
    s_lshr_b32 s40, s25, 2
    s_lshl_b32 s40, s40, 7
    s_add_u32 s40, s40, 6813696
    s_waitcnt vmcnt(0)
    s_mov_b32 s62, 40000
NT15:
    v_readfirstlane_b32 s60, v250
    s_nop 1
    s_cmp_ge_u32 s60, 8
    s_cbranch_scc1 ND15
    s_sub_u32 s62, s62, 1
    s_cbranch_scc1 ND15
    s_sleep 8
    global_load_dword v250, v255, s[92:93] sc1
    s_waitcnt vmcnt(0)
    s_branch NT15
ND15:
    v_mov_b32 v4, 1
    s_mov_b64 exec, 1
    buffer_atomic_add v4, v255, s[20:23], s37 offen sc1
    s_mov_b64 exec, -1
    s_cmp_ge_u32 s25, 16
    s_cbranch_scc1 C_END
    s_barrier
    ds_read_b64_tr_b16 v[16:17], v12 offset:0
    ds_read_b64_tr_b16 v[18:19], v12 offset:7168
    ds_read_b64_tr_b16 v[20:21], v12 offset:64
    ds_read_b64_tr_b16 v[22:23], v12 offset:7232
    ds_read_b64_tr_b16 v[24:25], v12 offset:128
    ds_read_b64_tr_b16 v[26:27], v12 offset:7296
    ds_read_b64_tr_b16 v[28:29], v12 offset:192
    ds_read_b64_tr_b16 v[30:31], v12 offset:7360
    ds_read_b64_tr_b16 v[32:33], v12 offset:256
    ds_read_b64_tr_b16 v[34:35], v12 offset:7424
    ds_read_b64_tr_b16 v[36:37], v12 offset:320
    ds_read_b64_tr_b16 v[38:39], v12 offset:7488
    ds_read_b64_tr_b16 v[40:41], v12 offset:384
    ds_read_b64_tr_b16 v[42:43], v12 offset:7552
    s_waitcnt lgkmcnt(0)
    s_cmp_eq_u32 s49, 0
    s_cbranch_scc1 C_WO2
    s_mov_b32 exec_lo, 0
    v_mov_b32 v18, 0
    v_mov_b32 v19, 0
    v_mov_b32 v22, 0
    v_mov_b32 v23, 0
    v_mov_b32 v26, 0
    v_mov_b32 v27, 0
    v_mov_b32 v30, 0
    v_mov_b32 v31, 0
    v_mov_b32 v34, 0
    v_mov_b32 v35, 0
    v_mov_b32 v38, 0
    v_mov_b32 v39, 0
    v_mov_b32 v42, 0
    v_mov_b32 v43, 0
    s_mov_b32 exec_lo, -1
C_WO2:
    buffer_store_dwordx4 v[16:19], v2, s[20:23], s38 offen sc1
    s_add_u32 s38, s38, 32768
    buffer_store_dwordx4 v[20:23], v2, s[20:23], s38 offen sc1
    s_add_u32 s38, s38, 32768
    buffer_store_dwordx4 v[24:27], v2, s[20:23], s38 offen sc1
    s_add_u32 s38, s38, 32768
    buffer_store_dwordx4 v[28:31], v2, s[20:23], s38 offen sc1
    s_add_u32 s38, s38, 32768
    buffer_store_dwordx4 v[32:35], v2, s[20:23], s38 offen sc1
    s_add_u32 s38, s38, 32768
    buffer_store_dwordx4 v[36:39], v2, s[20:23], s38 offen sc1
    s_add_u32 s38, s38, 32768
    buffer_store_dwordx4 v[40:43], v2, s[20:23], s38 offen sc1
    s_waitcnt vmcnt(0)
    v_mov_b32 v4, 1
    s_mov_b64 exec, 1
    buffer_atomic_add v4, v255, s[20:23], s40 offen sc1
    s_mov_b64 exec, -1
C_END:
L_END:
    s_endpgm
.section .rodata,"a"
.p2align 6
.amdhsa_kernel gated_mix__mha_block__ssm_conv_s4__prompt_kernel
  .amdhsa_next_free_vgpr 256
  .amdhsa_next_free_sgpr 102
  .amdhsa_accum_offset 256
  .amdhsa_group_segment_fixed_size 0
  .amdhsa_kernarg_size 128
  .amdhsa_user_sgpr_count 2
  .amdhsa_user_sgpr_kernarg_segment_ptr 1
  .amdhsa_system_sgpr_workgroup_id_x 1
.end_amdhsa_kernel
```
